```python
import torch

def _softmax(x, axis=-1):
    return torch.softmax(x, dim=axis)
def _gelu(x):
    return torch.nn.functional.gelu(x, approximate="tanh")
def _silu(x):
    return torch.nn.functional.silu(x)
def _sigmoid(x):
    return torch.sigmoid(x)
def _layernorm(x, axis=-1, eps=1e-5):
    m = x.mean(dim=axis, keepdim=True)
    v = x.var(dim=axis, keepdim=True, unbiased=False)
    return (x - m) / torch.sqrt(v + eps)
def _scatter_add(tgt, idx, src, axis=0):
    return tgt.clone().index_add_(axis, idx, src)
def _segment_sum(src, seg, n):
    out = torch.zeros((n,) + src.shape[1:], dtype=src.dtype)
    return out.index_add_(0, seg, src)
def _pad(x, pw):
    flat = tuple(v for pair in reversed(pw) for v in pair)
    return torch.nn.functional.pad(x, flat)

kernel_name = 'parallel_sum__ssm_conv_s4d__mixer_token_mlp__prompt'

def setup_inputs():

    _w = (lambda a: (lambda t: t.to(torch.bfloat16) if t.is_floating_point() else t)(torch.as_tensor(a)))
    def _A_setup():
        Bsz, L, D, N = 1, 2048, 640, 192
        return {
            "u": _w((lambda *s: torch.randn(*s, dtype=torch.bfloat16) * 0.05)(Bsz, L, D)),
            "log_A_real": _w((lambda *s: torch.randn(*s, dtype=torch.bfloat16) * 3.2)(D, N) * 0.5),
            "A_imag": _w((lambda *s: torch.randn(*s, dtype=torch.bfloat16) * 0.05)(D, N) * 3.14),
            "C_real": _w((lambda *s: torch.randn(*s, dtype=torch.bfloat16) * 0.1)(D, N) / N ** 0.5),
            "C_imag": _w((lambda *s: torch.randn(*s, dtype=torch.bfloat16) * 0.1)(D, N) / N ** 0.5),
            "log_dt": _w((lambda *s: torch.randn(*s, dtype=torch.bfloat16) * 0.05)(D) * 0.5 - 4.0),
            "D_skip": _w((lambda *s: torch.randn(*s, dtype=torch.bfloat16) * 0.05)(D)),
        }
    _A_in = _A_setup()

    def _B_setup():
        B, S, D, F = 1, 2048, 640, 1536
        return {
            "x": _w((lambda *s: torch.randn(*s, dtype=torch.bfloat16) * 0.05)(B, S, D)),
            "w1": _w((lambda *s: torch.randn(*s, dtype=torch.bfloat16) * 0.8)(S, F) * (S ** -0.5)),
            "b1": _w((lambda *s: torch.randn(*s, dtype=torch.bfloat16) * 3.2)(F) * 0.02),
            "w2": _w((lambda *s: torch.randn(*s, dtype=torch.bfloat16) * 0.4)(F, S) * (F ** -0.5)),
            "b2": _w((lambda *s: torch.randn(*s, dtype=torch.bfloat16) * 1.6)(S) * 0.02),
        }
    _B_in = _B_setup()

    return {
        "A_u": _A_in["u"],
        "A_log_A_real": _A_in["log_A_real"],
        "A_A_imag": _A_in["A_imag"],
        "A_C_real": _A_in["C_real"],
        "A_C_imag": _A_in["C_imag"],
        "A_log_dt": _A_in["log_dt"],
        "A_D_skip": _A_in["D_skip"],
        "B_x": _B_in["x"],
        "B_w1": _B_in["w1"],
        "B_b1": _B_in["b1"],
        "B_w2": _B_in["w2"],
        "B_b2": _B_in["b2"],
    }

def reference(A_u, A_log_A_real, A_A_imag, A_C_real, A_C_imag, A_log_dt, A_D_skip, B_x, B_w1, B_b1, B_w2, B_b2):
    def _A_ref(u, log_A_real, A_imag, C_real, C_imag, log_dt, D_skip):
        L = u.shape[1]
        dt = torch.exp(log_dt)
        A = -torch.exp(log_A_real) + 1j * A_imag
        C = (C_real + 1j * C_imag) * dt[:, None]
        pos = (lambda x, dt: x.to(dt))(torch.arange(L), log_dt.dtype)
        P = torch.exp((A * dt[:, None])[:, :, None] * pos[None, None, :])
        K = 2.0 * torch.einsum("dn,dnl->dl", C, P).real
        L2 = 2 * L
        u_t = (lambda x, *d: x.permute(*d))(u, 0, 2, 1)
        Kf = (lambda x, *a, **k: torch.fft.rfft(x.float(), *a, **k))(K, L2)
        Uf = (lambda x, *a, **k: torch.fft.rfft(x.float(), *a, **k))(u_t, L2)
        y = (lambda x, *a, **k: torch.fft.irfft(x, *a, **k).to(torch.bfloat16))(Uf * Kf[None, :, :], L2)[:, :, :L]
        y = (lambda x, *d: x.permute(*d))(y, 0, 2, 1)
        return y + u * D_skip[None, None, :]

    def _B_ref(x, w1, b1, w2, b2):
        B, S, D = x.shape
        h = _layernorm(x, axis=-1)
        u = torch.einsum("bsd,sf->bdf", h, w1) + b1
        u = _gelu(u)
        y = torch.einsum("bdf,fs->bds", u, w2) + b2
        return (lambda x, *d: x.permute(*d))(y, 0, 2, 1)

    x = A_u
    xn = _layernorm(x, axis=-1)
    return x + _A_ref(xn, A_log_A_real, A_A_imag, A_C_real, A_C_imag, A_log_dt, A_D_skip) + _B_ref(xn, B_w1, B_b1, B_w2, B_b2)
```

```asm
; @launch grid=(256,1,1) block=(512,1,1) lds=163840
.amdgcn_target "amdgcn-amd-amdhsa--gfx950"
.text
.globl parallel_sum__ssm_conv_s4d__mixer_token_mlp__prompt_kernel
.p2align 8
.type parallel_sum__ssm_conv_s4d__mixer_token_mlp__prompt_kernel,@function
parallel_sum__ssm_conv_s4d__mixer_token_mlp__prompt_kernel:
    s_cmp_ge_u32 s2, 256
    s_cbranch_scc1 L_end
    s_load_dwordx16 s[4:19], s[0:1], 0
    s_load_dwordx8 s[20:27], s[0:1], 64
    s_load_dwordx4 s[28:31], s[0:1], 96
    s_load_dwordx2 s[32:33], s[0:1], 112
    s_getpc_b64 s[70:71]
    s_lshr_b32 s72, s2, 3
    s_and_b32 s72, s72, 15
    s_lshl_b32 s72, s72, 3
    v_lshrrev_b32 v1, 6, v0
    v_add_u32 v1, s72, v1
    v_mul_u32_u24 v1, 4, v1
    v_and_b32 v3, 63, v0
    v_min_u32 v3, 3, v3
    v_add_lshl_u32 v1, v1, v3, 6
    global_load_dword v19, v1, s[70:71]
    v_lshrrev_b32 v1, 6, v0
    v_and_b32 v0, 63, v0
    v_readfirstlane_b32 s58, v1
    s_and_b32 s35, s2, 7
    s_lshl_b32 s35, s35, 5
    s_lshr_b32 s69, s2, 3
    s_add_u32 s35, s35, s69
    s_lshl_b32 s69, s35, 3
    v_add_u32_e64 v1, s69, v1
    v_mul_u32_u24 v1, 1280, v1
    v_lshl_add_u32 v3, v0, 2, v1
    s_and_b32 s70, s2, 7
    s_lshr_b32 s71, s2, 3
    s_mul_i32 s72, s71, 26
    s_lshr_b32 s72, s72, 8
    s_mul_i32 s73, s72, 10
    s_sub_u32 s73, s71, s73
    s_mov_b32 s60, s73
    s_mul_i32 s76, s70, 3
    s_add_u32 s61, s76, s72
    s_cmp_lt_u32 s72, 2
    s_cselect_b32 s64, 1, 0
    s_lshl_b32 s76, s70, 1
    s_add_u32 s76, s76, s72
    s_lshl_b32 s77, s60, 4
    s_add_u32 s63, s76, s77
    s_and_b32 s59, s58, 3
    v_lshrrev_b32 v12, 3, v0
    v_and_b32 v13, 7, v0
    v_mul_u32_u24 v14, 3072, v12
    v_and_b32 v15, 2, v12
    v_xor_b32 v16, v13, v15
    v_lshl_add_u32 v4, v16, 4, v14
    v_xor_b32 v16, v13, v15
    v_xor_b32 v16, 4, v16
    v_lshl_add_u32 v5, v16, 4, v14
    v_add_u32 v5, 23552, v5
    v_xor_b32_e64 v16, v13, v15
    v_lshl_add_u32 v6, v16, 4, v14
    v_add_u32 v6, 47104, v6
    v_xor_b32 v16, v13, v15
    v_xor_b32 v16, 4, v16
    v_lshl_add_u32 v7, v16, 4, v14
    v_add_u32 v7, 70656, v7
    s_mul_i32 s78, s59, 28672
    s_add_u32 s78, s78, 46336
    s_mul_i32 s3, s59, 1572864
    s_lshl_b32 s76, s61, 7
    s_add_u32 s3, s3, s76
    s_mul_i32 s75, s73, 26
    s_lshr_b32 s75, s75, 4
    s_mul_i32 s76, s70, 2
    s_add_u32 s75, s75, s76
    s_and_b32 s75, s75, 15
    s_mul_i32 s79, s75, 98304
    s_add_u32 s79, s79, s3
    s_mov_b32 m0, s78
    s_mov_b32 s46, 0x600000
    s_mov_b32 s47, 0x20000
    s_lshl_b32 s76, s63, 2
    s_add_u32 s76, s76, s59
    s_mul_i32 s77, s76, 384
    s_lshl_b32 s76, s76, 1
    v_lshl_add_u32 v8, v0, 2, s77
    v_lshl_add_u32 v9, v0, 1, s77
    v_mov_b32 v10, s76
    s_cmp_lt_u32 s71, 30
    s_cselect_b32 s62, 1, 0
    s_waitcnt lgkmcnt(0)
    global_load_dword v20, v3, s[4:5] offset:0
    global_load_dword v21, v3, s[4:5] offset:256
    global_load_dword v22, v3, s[4:5] offset:512
    global_load_dword v23, v3, s[4:5] offset:768
    global_load_dword v24, v3, s[4:5] offset:1024
    s_mov_b32 s44, s20
    s_and_b32 s45, s21, 0xffff
    s_cmp_ge_u32 s58, 4
    s_cbranch_scc1 L_pre_S
    s_barrier
    s_cmp_eq_u32 s62, 0
    s_cbranch_scc1 L_pre_G_idle
    buffer_load_dwordx4 v4, s[44:47], s79 offen offset:0 lds
    buffer_load_dwordx4 v5, s[44:47], s79 offen offset:1024 lds
    buffer_load_dwordx4 v6, s[44:47], s79 offen offset:2048 lds
    buffer_load_dwordx4 v7, s[44:47], s79 offen offset:3072 lds
    s_load_dwordx2 s[56:57], s[32:33], 0
    s_mov_b32 s67, 0xffff0000
    v_lshlrev_b32 v2, 2, v0
    v_mov_b32 v16, 0
    v_mov_b32 v17, 0
    v_mov_b32 v18, 0
    s_mov_b64 exec, 0xff
    ds_write_b32 v2, v16 offset:0
    s_mov_b64 exec, -1
    s_mov_b32 s40, s32
    s_and_b32 s41, s33, 0xffff
    s_mov_b32 s42, 0xe00000
    s_mov_b32 s43, 0x20000
    s_mov_b32 s36, s4
    s_and_b32 s37, s5, 0xffff
    s_mov_b32 s38, 0x280000
    s_mov_b32 s39, 0x20000
    s_mov_b32 s48, s24
    s_and_b32 s49, s25, 0xffff
    s_mov_b32 s50, 0x600000
    s_mov_b32 s51, 0x20000
    s_mov_b32 s52, s28
    s_and_b32 s53, s29, 0xffff
    s_mov_b32 s54, 0x280000
    s_mov_b32 s55, 0x20000
    s_and_b32 s74, s71, 7
    s_mov_b32 s65, s74
    s_lshl_b32 s76, s70, 2
    s_lshr_b32 s71, s71, 3
    s_add_u32 s66, s76, s71
    s_mov_b32 s18, 0x76543210
    s_mov_b32 s19, 0xfedcba98
    s_mul_i32 s79, s75, 0x01010101
    s_lshr_b32 s76, s18, 4
    s_and_b32 s76, s76, 0x0f0f0f0f
    s_add_u32 s76, s76, s79
    s_add_u32 s77, s76, 0x70707070
    s_and_b32 s77, s77, 0x80808080
    s_lshr_b32 s77, s77, 7
    s_mul_i32 s77, s77, 16
    s_sub_u32 s76, s76, s77
    s_and_b32 s18, s18, 0x0f0f0f0f
    s_add_u32 s18, s18, s79
    s_add_u32 s77, s18, 0x70707070
    s_and_b32 s77, s77, 0x80808080
    s_lshr_b32 s77, s77, 7
    s_mul_i32 s77, s77, 16
    s_sub_u32 s18, s18, s77
    s_lshl_b32 s76, s76, 4
    s_or_b32 s18, s18, s76
    s_lshr_b32 s76, s19, 4
    s_and_b32 s76, s76, 0x0f0f0f0f
    s_add_u32 s76, s76, s79
    s_add_u32 s77, s76, 0x70707070
    s_and_b32 s77, s77, 0x80808080
    s_lshr_b32 s77, s77, 7
    s_mul_i32 s77, s77, 16
    s_sub_u32 s76, s76, s77
    s_and_b32 s19, s19, 0x0f0f0f0f
    s_add_u32 s19, s19, s79
    s_add_u32 s77, s19, 0x70707070
    s_and_b32 s77, s77, 0x80808080
    s_lshr_b32 s77, s77, 7
    s_mul_i32 s77, s77, 16
    s_sub_u32 s19, s19, s77
    s_lshl_b32 s76, s76, 4
    s_or_b32 s19, s19, s76
    s_mov_b32 s71, s74
    s_mul_i32 s70, s70, 3
    s_lshr_b32 s70, s70, 1
    s_mov_b32 s9, s70
    s_mov_b32 s34, 0x76543210
    s_mov_b32 s35, 0xba98
    s_cmp_eq_u32 s71, 1
    s_cselect_b32 s34, 0x87653210, s34
    s_cselect_b32 s35, 0x4ba9, s35
    s_cmp_eq_u32 s71, 2
    s_cselect_b32 s34, 0x98763210, s34
    s_cselect_b32 s35, 0x54ba, s35
    s_cmp_eq_u32 s71, 3
    s_cselect_b32 s34, 0xa9873210, s34
    s_cselect_b32 s35, 0x654b, s35
    s_cmp_eq_u32 s71, 4
    s_cselect_b32 s34, 0xba983210, s34
    s_cselect_b32 s35, 0x7654, s35
    s_cmp_eq_u32 s71, 5
    s_cselect_b32 s34, 0x4ba93210, s34
    s_cselect_b32 s35, 0x8765, s35
    s_cmp_eq_u32 s71, 6
    s_cselect_b32 s34, 0x54ba3210, s34
    s_cselect_b32 s35, 0x9876, s35
    s_cmp_eq_u32 s71, 7
    s_cselect_b32 s34, 0x654b3210, s34
    s_cselect_b32 s35, 0xa987, s35
    s_mul_i32 s79, s70, 0x01010101
    s_lshr_b32 s76, s34, 4
    s_and_b32 s76, s76, 0x0f0f0f0f
    s_add_u32 s76, s76, s79
    s_add_u32 s77, s76, 0x74747474
    s_and_b32 s77, s77, 0x80808080
    s_lshr_b32 s77, s77, 7
    s_mul_i32 s77, s77, 12
    s_sub_u32 s76, s76, s77
    s_and_b32 s34, s34, 0x0f0f0f0f
    s_add_u32 s34, s34, s79
    s_add_u32 s77, s34, 0x74747474
    s_and_b32 s77, s77, 0x80808080
    s_lshr_b32 s77, s77, 7
    s_mul_i32 s77, s77, 12
    s_sub_u32 s34, s34, s77
    s_lshl_b32 s76, s76, 4
    s_or_b32 s34, s34, s76
    s_lshr_b32 s76, s35, 4
    s_and_b32 s76, s76, 0x0f0f0f0f
    s_add_u32 s76, s76, s79
    s_add_u32 s77, s76, 0x74747474
    s_and_b32 s77, s77, 0x80808080
    s_lshr_b32 s77, s77, 7
    s_mul_i32 s77, s77, 12
    s_sub_u32 s76, s76, s77
    s_and_b32 s35, s35, 0x0f0f0f0f
    s_add_u32 s35, s35, s79
    s_add_u32 s77, s35, 0x74747474
    s_and_b32 s77, s77, 0x80808080
    s_lshr_b32 s77, s77, 7
    s_mul_i32 s77, s77, 12
    s_sub_u32 s35, s35, s77
    s_lshl_b32 s76, s76, 4
    s_or_b32 s35, s35, s76
    v_lshrrev_b32 v12, 4, v0
    v_bfe_u32 v13, v0, 2, 2
    v_and_b32_e64 v14, 3, v0
    v_lshl_add_u32 v15, v12, 3, v13
    v_lshrrev_b32 v16, 1, v13
    v_and_b32 v17, 1, v12
    v_lshl_or_b32 v16, v17, 1, v16
    v_lshlrev_b32_e64 v15, 7, v15
    v_lshl_add_u32 v15, v14, 3, v15
    v_add_u32 v15, s78, v15
    v_xor_b32 v17, 0, v16
    v_lshl_add_u32 v8, v17, 5, v15
    v_xor_b32_e64 v17, 1, v16
    v_lshl_add_u32 v9, v17, 5, v15
    v_xor_b32_e64 v17, 2, v16
    v_lshl_add_u32 v10, v17, 5, v15
    v_xor_b32_e64 v17, 3, v16
    v_lshl_add_u32 v11, v17, 5, v15
    s_lshl_b32 s76, s61, 7
    v_mov_b32 v12, s76
    s_lshl_b32 s76, s66, 7
    v_mov_b32 v13, s76
    s_bfe_u32 s79, s18, 0x40004
    s_mul_i32 s79, s79, 98304
    s_add_u32 s79, s79, s3
    s_add_u32 m0, s78, 4096
    s_waitcnt vmcnt(4)
    buffer_load_dwordx4 v4, s[44:47], s79 offen offset:0 lds
    buffer_load_dwordx4 v5, s[44:47], s79 offen offset:1024 lds
    buffer_load_dwordx4 v6, s[44:47], s79 offen offset:2048 lds
    buffer_load_dwordx4 v7, s[44:47], s79 offen offset:3072 lds
    global_load_dword v18, v12, s[22:23]
    global_load_dword v18, v13, s[26:27]
    s_lshl_b32 s76, s2, 2
    s_add_u32 s76, s76, s59
    s_and_b32 s76, s76, 127
    s_lshl_b32 s76, s76, 7
    v_min_u32 v12, 3, v0
    v_lshlrev_b32 v13, 17, v12
    v_cmp_eq_u32_e64 vcc, 3, v12
    s_nop 1
    v_cndmask_b32 v12, 0, 1, vcc
    v_lshlrev_b32 v12, 16, v12
    v_sub_u32 v12, v13, v12
    v_add_u32 v12, 0x10000, v12
    buffer_load_dword v18, v12, s[40:43], s76 offen
    s_branch L_ln
L_pre_G_idle:
    s_load_dwordx2 s[56:57], s[32:33], 0
    s_mov_b32 s67, 0xffff0000
    v_lshlrev_b32 v2, 2, v0
    v_mov_b32 v16, 0
    v_mov_b32 v17, 0
    v_mov_b32_e64 v18, 0
    s_mov_b64 exec, 0xff
    ds_write_b32 v2, v16 offset:0
    s_mov_b64 exec, -1
    s_mov_b32 s40, s32
    s_and_b32 s41, s33, 0xffff
    s_mov_b32 s42, 0xe00000
    s_mov_b32 s43, 0x20000
    s_mov_b32 s36, s4
    s_and_b32 s37, s5, 0xffff
    s_mov_b32 s38, 0x280000
    s_mov_b32 s39, 0x20000
    s_mov_b32 s48, s24
    s_and_b32 s49, s25, 0xffff
    s_mov_b32 s50, 0x600000
    s_mov_b32 s51, 0x20000
    s_mov_b32 s52, s28
    s_and_b32 s53, s29, 0xffff
    s_mov_b32 s54, 0x280000
    s_mov_b32 s55, 0x20000
    s_and_b32 s74, s71, 7
    s_mov_b32 s65, s74
    s_lshl_b32 s76, s70, 2
    s_lshr_b32 s71, s71, 3
    s_add_u32 s66, s76, s71
    s_mov_b32 s71, s74
    s_mul_i32 s70, s70, 3
    s_lshr_b32 s70, s70, 1
    s_mov_b32 s9, s70
    s_mov_b32 s34, 0x76543210
    s_mov_b32 s35, 0xba98
    s_cmp_eq_u32 s71, 1
    s_cselect_b32 s34, 0x87653210, s34
    s_cselect_b32 s35, 0x4ba9, s35
    s_cmp_eq_u32 s71, 2
    s_cselect_b32 s34, 0x98763210, s34
    s_cselect_b32 s35, 0x54ba, s35
    s_cmp_eq_u32 s71, 3
    s_cselect_b32 s34, 0xa9873210, s34
    s_cselect_b32 s35, 0x654b, s35
    s_cmp_eq_u32 s71, 4
    s_cselect_b32 s34, 0xba983210, s34
    s_cselect_b32 s35, 0x7654, s35
    s_cmp_eq_u32 s71, 5
    s_cselect_b32 s34, 0x4ba93210, s34
    s_cselect_b32 s35, 0x8765, s35
    s_cmp_eq_u32 s71, 6
    s_cselect_b32 s34, 0x54ba3210, s34
    s_cselect_b32 s35, 0x9876, s35
    s_cmp_eq_u32 s71, 7
    s_cselect_b32 s34, 0x654b3210, s34
    s_cselect_b32 s35, 0xa987, s35
    s_mul_i32 s79, s70, 0x01010101
    s_lshr_b32 s76, s34, 4
    s_and_b32 s76, s76, 0x0f0f0f0f
    s_add_u32 s76, s76, s79
    s_add_u32 s77, s76, 0x74747474
    s_and_b32 s77, s77, 0x80808080
    s_lshr_b32 s77, s77, 7
    s_mul_i32 s77, s77, 12
    s_sub_u32 s76, s76, s77
    s_and_b32 s34, s34, 0x0f0f0f0f
    s_add_u32 s34, s34, s79
    s_add_u32 s77, s34, 0x74747474
    s_and_b32 s77, s77, 0x80808080
    s_lshr_b32 s77, s77, 7
    s_mul_i32 s77, s77, 12
    s_sub_u32 s34, s34, s77
    s_lshl_b32 s76, s76, 4
    s_or_b32 s34, s34, s76
    s_lshr_b32 s76, s35, 4
    s_and_b32 s76, s76, 0x0f0f0f0f
    s_add_u32 s76, s76, s79
    s_add_u32 s77, s76, 0x74747474
    s_and_b32 s77, s77, 0x80808080
    s_lshr_b32 s77, s77, 7
    s_mul_i32 s77, s77, 12
    s_sub_u32 s76, s76, s77
    s_and_b32 s35, s35, 0x0f0f0f0f
    s_add_u32 s35, s35, s79
    s_add_u32 s77, s35, 0x74747474
    s_and_b32 s77, s77, 0x80808080
    s_lshr_b32 s77, s77, 7
    s_mul_i32 s77, s77, 12
    s_sub_u32 s35, s35, s77
    s_lshl_b32 s76, s76, 4
    s_or_b32 s35, s35, s76
    s_waitcnt vmcnt(0)
    s_branch L_ln
L_pre_S:
    s_cmp_lg_u32 s64, 0
    s_cbranch_scc1 L_pre_S_cv
    s_barrier
    s_load_dwordx2 s[56:57], s[32:33], 0
    s_mov_b32 s67, 0xffff0000
    v_lshlrev_b32 v2, 2, v0
    v_mov_b32 v16, 0
    v_mov_b32 v17, 0
    v_mov_b32 v18, 0
    s_mov_b64 exec, 0xff
    ds_write_b32 v2, v16 offset:0
    s_mov_b64 exec, -1
    s_mov_b32 s40, s32
    s_and_b32 s41, s33, 0xffff
    s_mov_b32 s42, 0xe00000
    s_mov_b32 s43, 0x20000
    s_mov_b32 s36, s4
    s_and_b32 s37, s5, 0xffff
    s_mov_b32 s38, 0x280000
    s_mov_b32 s39, 0x20000
    s_mov_b32 s48, s24
    s_and_b32 s49, s25, 0xffff
    s_mov_b32 s50, 0x600000
    s_mov_b32 s51, 0x20000
    s_mov_b32 s52, s28
    s_and_b32 s53, s29, 0xffff
    s_mov_b32 s54, 0x280000
    s_mov_b32 s55, 0x20000
    s_and_b32 s74, s71, 7
    s_mov_b32 s65, s74
    s_lshl_b32 s76, s70, 2
    s_lshr_b32 s71, s71, 3
    s_add_u32 s66, s76, s71
    v_lshrrev_b32_e64 v12, 4, v0
    v_bfe_u32 v13, v0, 2, 2
    v_and_b32 v14, 3, v0
    v_and_b32 v15, 15, v0
    v_mul_u32_u24 v16, 1344, v13
    v_lshl_add_u32 v16, v12, 5, v16
    v_lshl_add_u32 v16, v14, 3, v16
    s_lshl_b32 s70, s59, 7
    s_add_u32 s70, s70, 18688
    v_add_u32 v16, s70, v16
    s_lshr_b32 s70, s35, 6
    v_subrev_u32 v17, s70, v12
    v_and_b32 v17, 3, v17
    v_lshlrev_b32 v17, 10, v17
    v_lshl_add_u32 v17, v15, 4, v17
    s_lshr_b32 s70, s35, 2
    s_lshl_b32 s70, s70, 12
    s_and_b32 s71, s35, 3
    s_lshl_b32 s71, s71, 8
    s_add_u32 s70, s70, s71
    s_lshl_b32 s71, s59, 18
    s_add_u32 s70, s70, s71
    s_add_u32 s75, s70, 0x100000
    v_lshrrev_b32 v18, 2, v0
    v_lshlrev_b32_e64 v18, 14, v18
    v_lshl_add_u32 v18, v14, 4, v18
    s_lshl_b32 s70, s35, 6
    s_add_u32 s71, s71, s70
    s_add_u32 s76, s71, 0x400000
    s_lshl_b32 s70, s59, 8
    s_add_u32 s70, s70, s35
    s_mul_i32 s70, s70, 16
    s_add_u32 s69, s70, 0x10000
    s_mov_b32 s3, 0x8000000
    s_cmp_lt_u32 s59, 2
    s_cselect_b32 s3, 0x200000, s3
    s_waitcnt vmcnt(0)
    s_branch L_ln
L_pre_S_cv:
    global_load_dword v238, v8, s[6:7]
    global_load_dword v239, v8, s[8:9]
    global_load_dword v240, v8, s[10:11]
    global_load_dword v241, v8, s[12:13]
    global_load_ushort v246, v9, s[6:7] offset:256
    global_load_ushort v247, v9, s[8:9] offset:256
    global_load_ushort v248, v9, s[10:11] offset:256
    global_load_ushort v249, v9, s[12:13] offset:256
    global_load_ushort v250, v10, s[14:15]
    global_load_ushort v251, v10, s[16:17]
    s_barrier
    s_load_dwordx2 s[56:57], s[32:33], 0
    s_mov_b32 s67, 0xffff0000
    v_lshlrev_b32 v2, 2, v0
    v_mov_b32 v16, 0
    v_mov_b32 v17, 0
    v_mov_b32_e64 v18, 0
    s_mov_b64 exec, 0xff
    ds_write_b32 v2, v16 offset:0
    s_mov_b64 exec, -1
    s_mov_b32 s40, s32
    s_and_b32 s41, s33, 0xffff
    s_mov_b32 s42, 0xe00000
    s_mov_b32 s43, 0x20000
    s_mov_b32 s36, s4
    s_and_b32 s37, s5, 0xffff
    s_mov_b32 s38, 0x280000
    s_mov_b32 s39, 0x20000
    s_mov_b32 s48, s24
    s_and_b32 s49, s25, 0xffff
    s_mov_b32 s50, 0x600000
    s_mov_b32 s51, 0x20000
    s_mov_b32 s52, s28
    s_and_b32 s53, s29, 0xffff
    s_mov_b32 s54, 0x280000
    s_mov_b32 s55, 0x20000
    s_and_b32 s74, s71, 7
    s_mov_b32 s65, s74
    s_lshl_b32 s76, s70, 2
    s_lshr_b32 s71, s71, 3
    s_add_u32 s66, s76, s71
    s_mul_i32 s78, s59, 4608
    s_add_u32 s78, s78, 256
    s_mul_i32 s79, s59, 1536
    s_add_u32 s79, s79, 40192
    v_lshlrev_b32_e64 v5, 1, v0
    v_sub_u32 v5, 1151, v5
    v_bfe_u32 v6, v5, 3, 1
    v_add3_u32 v5, v5, v6, 3
    v_lshrrev_b32_e64 v5, 3, v5
    v_add_u32 v5, 384, v5
    v_lshlrev_b32 v5, 1, v5
    v_add_u32 v60, s79, v5
    v_lshlrev_b32_e64 v5, 1, v0
    v_sub_u32 v5, 1150, v5
    v_bfe_u32 v6, v5, 3, 1
    v_add3_u32 v5, v5, v6, 3
    v_lshrrev_b32_e64 v5, 3, v5
    v_add_u32 v5, 384, v5
    v_lshlrev_b32 v5, 1, v5
    v_add_u32 v61, s79, v5
    v_lshlrev_b32_e64 v5, 1, v0
    v_sub_u32 v5, 639, v5
    v_bfe_u32 v6, v5, 2, 1
    v_add3_u32 v5, v5, v6, 1
    v_lshrrev_b32_e64 v5, 2, v5
    v_add_u32 v5, 256, v5
    v_lshlrev_b32 v5, 1, v5
    v_add_u32 v62, s79, v5
    v_lshlrev_b32_e64 v5, 1, v0
    v_sub_u32 v5, 638, v5
    v_bfe_u32 v6, v5, 2, 1
    v_add3_u32 v5, v5, v6, 1
    v_lshrrev_b32_e64 v5, 2, v5
    v_add_u32 v5, 256, v5
    v_lshlrev_b32 v5, 1, v5
    v_add_u32 v63, s79, v5
    v_lshlrev_b32_e64 v5, 1, v0
    v_sub_u32 v5, 383, v5
    v_bfe_u32 v6, v5, 1, 1
    v_add3_u32 v5, v5, v6, 0
    v_lshrrev_b32_e64 v5, 1, v5
    v_add_u32 v5, 128, v5
    v_lshlrev_b32 v5, 1, v5
    v_add_u32 v64, s79, v5
    v_lshlrev_b32_e64 v5, 1, v0
    v_sub_u32 v5, 382, v5
    v_bfe_u32 v6, v5, 1, 1
    v_add3_u32 v5, v5, v6, 0
    v_lshrrev_b32_e64 v5, 1, v5
    v_add_u32 v5, 128, v5
    v_lshlrev_b32 v5, 1, v5
    v_add_u32 v65, s79, v5
    v_lshlrev_b32_e64 v5, 1, v0
    v_sub_u32 v5, 127, v5
    v_add_u32 v5, 0, v5
    v_lshlrev_b32 v5, 1, v5
    v_add_u32 v66, s79, v5
    v_lshlrev_b32 v5, 1, v0
    v_sub_u32 v5, 126, v5
    v_add_u32 v5, 0, v5
    v_lshlrev_b32 v5, 1, v5
    v_add_u32 v67, s79, v5
    v_and_b32 v5, 15, v0
    v_lshrrev_b32_e64 v6, 4, v0
    v_mul_u32_u24 v69, 288, v5
    v_lshl_add_u32 v69, v6, 4, v69
    v_add_u32 v69, s78, v69
    v_lshrrev_b32 v7, 1, v6
    v_and_b32 v8, 1, v6
    v_lshlrev_b32 v9, 8, v7
    v_lshl_add_u32 v9, v5, 4, v9
    v_lshl_add_u32 v9, v8, 3, v9
    v_add_u32 v70, s79, v9
    v_lshlrev_b32 v9, 7, v6
    v_sub_u32 v10, 3, v7
    v_lshlrev_b32 v10, v10, v5
    v_add3_u32 v9, v9, v10, s79
    v_add_u32 v71, 512, v9
    v_mul_u32_u24_e64 v10, 60, v7
    v_add3_u32 v72, v71, v10, 4
    v_lshlrev_b32_e64 v9, 7, v6
    v_lshl_add_u32 v9, v5, 1, v9
    v_add_u32_e64 v9, s79, v9
    v_add_u32 v73, 1024, v9
    v_lshrrev_b32 v7, 1, v5
    v_lshlrev_b32 v8, 2, v6
    v_sub_u32 v8, v8, v7
    v_lshlrev_b32 v8, 2, v8
    v_and_b32 v9, 1, v5
    v_xor_b32 v9, 1, v9
    v_mul_u32_u24 v9, 2240, v9
    v_add3_u32 v8, v8, v9, s78
    v_add_u32 v74, 1564, v8
    v_add_u32 v75, 540, v8
    s_mul_i32 s77, s59, 4640
    s_add_u32 s77, s77, 19168
    v_lshl_add_u32 v8, v5, 1, v6
    v_lshlrev_b32 v8, 4, v8
    v_add_u32 v68, s77, v8
    v_lshrrev_b32_e64 v12, 4, v0
    v_bfe_u32 v13, v0, 2, 2
    v_and_b32 v14, 3, v0
    v_and_b32 v15, 15, v0
    v_mul_u32_u24 v16, 1344, v13
    v_lshl_add_u32 v16, v12, 5, v16
    v_lshl_add_u32 v16, v14, 3, v16
    s_lshl_b32 s70, s59, 7
    s_add_u32 s70, s70, 18688
    v_add_u32 v16, s70, v16
    s_lshr_b32 s70, s35, 6
    v_subrev_u32 v17, s70, v12
    v_and_b32 v17, 3, v17
    v_lshlrev_b32 v17, 10, v17
    v_lshl_add_u32 v17, v15, 4, v17
    s_lshr_b32 s70, s35, 2
    s_lshl_b32 s70, s70, 12
    s_and_b32 s71, s35, 3
    s_lshl_b32 s71, s71, 8
    s_add_u32 s70, s70, s71
    s_lshl_b32 s71, s59, 18
    s_add_u32 s70, s70, s71
    s_add_u32 s75, s70, 0x100000
    v_lshrrev_b32 v18, 2, v0
    v_lshlrev_b32_e64 v18, 14, v18
    v_lshl_add_u32 v18, v14, 4, v18
    s_lshl_b32 s70, s35, 6
    s_add_u32 s71, s71, s70
    s_add_u32 s76, s71, 0x400000
    s_lshl_b32 s70, s59, 8
    s_add_u32 s70, s70, s35
    s_mul_i32 s70, s70, 16
    s_add_u32 s69, s70, 0x10000
    s_mov_b32 s3, 0x8000000
    s_cmp_lt_u32 s59, 2
    s_cselect_b32 s3, 0x200000, s3
    s_waitcnt vmcnt(10)
L_ln:
    s_nop 0
    s_mul_i32 s74, s58, 1344
    s_add_u32 m0, s74, 18688
    s_mov_b32 s71, 0x3f803f80
    v_dot2_f32_bf16 v50, v20, s71, 0
    v_dot2_f32_bf16 v54, v20, v20, 0
    v_dot2_f32_bf16 v50, v21, s71, v50
    v_dot2_f32_bf16 v54, v21, v21, v54
    v_dot2_f32_bf16 v50, v22, s71, v50
    v_dot2_f32_bf16 v54, v22, v22, v54
    v_dot2_f32_bf16 v50, v23, s71, v50
    v_dot2_f32_bf16 v54, v23, v23, v54
    v_dot2_f32_bf16 v50, v24, s71, v50
    v_dot2_f32_bf16 v54, v24, v24, v54
    v_lshlrev_b32 v30, 16, v20
    v_and_b32 v31, s67, v20
    v_lshlrev_b32_e64 v32, 16, v21
    v_add_f32_dpp v50, v50, v50 row_ror:8 row_mask:0xf bank_mask:0xf
    v_add_f32_dpp v54, v54, v54 row_ror:8 row_mask:0xf bank_mask:0xf
    v_and_b32_e64 v33, s67, v21
    v_add_f32_dpp v50, v50, v50 row_ror:4 row_mask:0xf bank_mask:0xf
    v_add_f32_dpp v54, v54, v54 row_ror:4 row_mask:0xf bank_mask:0xf
    v_lshlrev_b32_e64 v34, 16, v22
    v_add_f32_dpp v50, v50, v50 row_ror:2 row_mask:0xf bank_mask:0xf
    v_add_f32_dpp v54, v54, v54 row_ror:2 row_mask:0xf bank_mask:0xf
    v_and_b32_e64 v35, s67, v22
    v_add_f32_dpp v50, v50, v50 row_ror:1 row_mask:0xf bank_mask:0xf
    v_add_f32_dpp v54, v54, v54 row_ror:1 row_mask:0xf bank_mask:0xf
    v_lshlrev_b32_e64 v36, 16, v23
    v_add_f32_dpp v50, v50, v50 row_bcast:15 row_mask:0xa bank_mask:0xf
    v_add_f32_dpp v54, v54, v54 row_bcast:15 row_mask:0xa bank_mask:0xf
    v_and_b32_e64 v37, s67, v23
    v_add_f32_dpp v50, v50, v50 row_bcast:31 row_mask:0xc bank_mask:0xf
    v_add_f32_dpp v54, v54, v54 row_bcast:31 row_mask:0xc bank_mask:0xf
    v_lshlrev_b32_e64 v38, 16, v24
    v_readlane_b32 s72, v50, 63
    v_readlane_b32 s73, v54, 63
    v_and_b32_e64 v39, s67, v24
    v_mov_b32 v52, 0x3acccccd
    v_mul_f32 v50, s72, v52
    v_mul_f32 v51, s73, v52
    v_fma_f32 v51, -v50, v50, v51
    v_max_f32_e64 v51, 0, v51
    v_cvt_pk_bf16_f32 v51, v50, v51
    v_lshlrev_b32 v50, 16, v51
    v_and_b32 v54, s67, v51
    v_add_f32 v54, 0x3727c5ac, v54
    v_cvt_pk_bf16_f32 v54, v54, v54
    v_and_b32 v54, s67, v54
    v_sqrt_f32 v54, v54
    v_pk_add_f32 v[30:31], v[30:31], v[50:51] op_sel_hi:[1,0] neg_lo:[0,1] neg_hi:[0,1]
    v_pk_add_f32 v[32:33], v[32:33], v[50:51] op_sel_hi:[1,0] neg_lo:[0,1] neg_hi:[0,1]
    v_pk_add_f32 v[34:35], v[34:35], v[50:51] op_sel_hi:[1,0] neg_lo:[0,1] neg_hi:[0,1]
    v_pk_add_f32 v[36:37], v[36:37], v[50:51] op_sel_hi:[1,0] neg_lo:[0,1] neg_hi:[0,1]
    v_pk_add_f32 v[38:39], v[38:39], v[50:51] op_sel_hi:[1,0] neg_lo:[0,1] neg_hi:[0,1]
    v_cvt_pk_bf16_f32 v54, v54, v54
    v_and_b32 v54, s67, v54
    v_rcp_f32 v52, v54
    v_cvt_pk_bf16_f32 v20, v30, v31
    v_cvt_pk_bf16_f32 v21, v32, v33
    v_cvt_pk_bf16_f32 v22, v34, v35
    v_cvt_pk_bf16_f32 v23, v36, v37
    v_cvt_pk_bf16_f32 v24, v38, v39
    v_lshlrev_b32 v30, 16, v20
    v_and_b32 v31, s67, v20
    v_lshlrev_b32 v32, 16, v21
    v_and_b32 v33, s67, v21
    v_lshlrev_b32 v34, 16, v22
    v_and_b32 v35, s67, v22
    v_lshlrev_b32 v36, 16, v23
    v_and_b32 v37, s67, v23
    v_lshlrev_b32 v38, 16, v24
    v_and_b32 v39, s67, v24
    v_pk_mul_f32 v[30:31], v[30:31], v[52:53] op_sel_hi:[1,0]
    v_pk_mul_f32 v[32:33], v[32:33], v[52:53] op_sel_hi:[1,0]
    v_pk_mul_f32 v[34:35], v[34:35], v[52:53] op_sel_hi:[1,0]
    v_pk_mul_f32 v[36:37], v[36:37], v[52:53] op_sel_hi:[1,0]
    v_pk_mul_f32 v[38:39], v[38:39], v[52:53] op_sel_hi:[1,0]
    v_cvt_pk_bf16_f32 v25, v30, v31
    v_cvt_pk_bf16_f32 v26, v32, v33
    v_cvt_pk_bf16_f32 v27, v34, v35
    v_cvt_pk_bf16_f32 v28, v36, v37
    v_cvt_pk_bf16_f32 v29, v38, v39
    ds_write_addtid_b32 v25 offset:0
    ds_write_addtid_b32 v26 offset:256
    ds_write_addtid_b32 v27 offset:512
    ds_write_addtid_b32 v28 offset:768
    ds_write_addtid_b32 v29 offset:1024
    v_dot2_f32_bf16 v50, v25, s71, 0
    v_dot2_f32_bf16 v54, v25, v25, 0
    v_dot2_f32_bf16 v50, v26, s71, v50
    v_dot2_f32_bf16 v54, v26, v26, v54
    v_dot2_f32_bf16 v50, v27, s71, v50
    v_dot2_f32_bf16 v54, v27, v27, v54
    v_dot2_f32_bf16 v50, v28, s71, v50
    v_dot2_f32_bf16 v54, v28, v28, v54
    v_dot2_f32_bf16 v50, v29, s71, v50
    v_dot2_f32_bf16 v54, v29, v29, v54
    v_lshlrev_b32 v30, 16, v25
    v_and_b32 v31, s67, v25
    v_lshlrev_b32_e64 v32, 16, v26
    v_add_f32_dpp v50, v50, v50 row_ror:8 row_mask:0xf bank_mask:0xf
    v_add_f32_dpp v54, v54, v54 row_ror:8 row_mask:0xf bank_mask:0xf
    v_and_b32_e64 v33, s67, v26
    v_add_f32_dpp v50, v50, v50 row_ror:4 row_mask:0xf bank_mask:0xf
    v_add_f32_dpp v54, v54, v54 row_ror:4 row_mask:0xf bank_mask:0xf
    v_lshlrev_b32_e64 v34, 16, v27
    v_add_f32_dpp v50, v50, v50 row_ror:2 row_mask:0xf bank_mask:0xf
    v_add_f32_dpp v54, v54, v54 row_ror:2 row_mask:0xf bank_mask:0xf
    v_and_b32_e64 v35, s67, v27
    v_add_f32_dpp v50, v50, v50 row_ror:1 row_mask:0xf bank_mask:0xf
    v_add_f32_dpp v54, v54, v54 row_ror:1 row_mask:0xf bank_mask:0xf
    v_lshlrev_b32_e64 v36, 16, v28
    v_add_f32_dpp v50, v50, v50 row_bcast:15 row_mask:0xa bank_mask:0xf
    v_add_f32_dpp v54, v54, v54 row_bcast:15 row_mask:0xa bank_mask:0xf
    v_and_b32_e64 v37, s67, v28
    v_add_f32_dpp v50, v50, v50 row_bcast:31 row_mask:0xc bank_mask:0xf
    v_add_f32_dpp v54, v54, v54 row_bcast:31 row_mask:0xc bank_mask:0xf
    v_lshlrev_b32_e64 v38, 16, v29
    v_readlane_b32 s72, v50, 63
    v_readlane_b32 s73, v54, 63
    v_and_b32_e64 v39, s67, v29
    v_mov_b32 v52, 0x3acccccd
    v_mul_f32 v50, s72, v52
    v_mul_f32 v51, s73, v52
    v_fma_f32 v51, -v50, v50, v51
    v_max_f32_e64 v51, 0, v51
    v_cvt_pk_bf16_f32 v51, v50, v51
    v_lshlrev_b32 v50, 16, v51
    v_and_b32 v54, s67, v51
    v_add_f32 v54, 0x3727c5ac, v54
    v_cvt_pk_bf16_f32 v54, v54, v54
    v_and_b32 v54, s67, v54
    v_sqrt_f32 v54, v54
    v_pk_add_f32 v[30:31], v[30:31], v[50:51] op_sel_hi:[1,0] neg_lo:[0,1] neg_hi:[0,1]
    v_pk_add_f32 v[32:33], v[32:33], v[50:51] op_sel_hi:[1,0] neg_lo:[0,1] neg_hi:[0,1]
    v_pk_add_f32 v[34:35], v[34:35], v[50:51] op_sel_hi:[1,0] neg_lo:[0,1] neg_hi:[0,1]
    v_pk_add_f32 v[36:37], v[36:37], v[50:51] op_sel_hi:[1,0] neg_lo:[0,1] neg_hi:[0,1]
    v_pk_add_f32 v[38:39], v[38:39], v[50:51] op_sel_hi:[1,0] neg_lo:[0,1] neg_hi:[0,1]
    v_cvt_pk_bf16_f32 v54, v54, v54
    v_and_b32 v54, s67, v54
    v_rcp_f32 v52, v54
    v_cvt_pk_bf16_f32 v25, v30, v31
    v_cvt_pk_bf16_f32 v26, v32, v33
    v_cvt_pk_bf16_f32 v27, v34, v35
    v_cvt_pk_bf16_f32 v28, v36, v37
    v_cvt_pk_bf16_f32 v29, v38, v39
    v_lshlrev_b32 v30, 16, v25
    v_and_b32 v31, s67, v25
    v_lshlrev_b32 v32, 16, v26
    v_and_b32 v33, s67, v26
    v_lshlrev_b32 v34, 16, v27
    v_and_b32 v35, s67, v27
    v_lshlrev_b32 v36, 16, v28
    v_and_b32 v37, s67, v28
    v_lshlrev_b32 v38, 16, v29
    v_and_b32 v39, s67, v29
    v_pk_mul_f32 v[30:31], v[30:31], v[52:53] op_sel_hi:[1,0]
    v_pk_mul_f32 v[32:33], v[32:33], v[52:53] op_sel_hi:[1,0]
    v_pk_mul_f32 v[34:35], v[34:35], v[52:53] op_sel_hi:[1,0]
    v_pk_mul_f32 v[36:37], v[36:37], v[52:53] op_sel_hi:[1,0]
    v_pk_mul_f32 v[38:39], v[38:39], v[52:53] op_sel_hi:[1,0]
    v_cvt_pk_bf16_f32 v30, v30, v31
    v_cvt_pk_bf16_f32 v31, v32, v33
    v_cvt_pk_bf16_f32 v32, v34, v35
    v_cvt_pk_bf16_f32 v33, v36, v37
    v_cvt_pk_bf16_f32 v34, v38, v39
    ds_write_addtid_b32 v30 offset:10752
    ds_write_addtid_b32 v31 offset:11008
    ds_write_addtid_b32 v32 offset:11264
    ds_write_addtid_b32 v33 offset:11520
    ds_write_addtid_b32 v34 offset:11776
    s_waitcnt lgkmcnt(0)
    s_add_u32 s56, s56, 1
    s_addc_u32 s57, s57, 0
    s_barrier
    s_cmp_ge_u32 s58, 4
    s_cbranch_scc1 L_S
    s_setprio 2
    v_mov_b32 v1, 0
    v_mov_b32 v3, 1
    v_lshlrev_b32_e64 v2, 4, v0
    s_cmp_eq_u32 s62, 0
    s_cbranch_scc1 L_G_idle
    s_mov_b32 s68, 0
L_lw_1:
    ds_read_b32 v12, v1 offset:0
    s_waitcnt lgkmcnt(0)
    v_readfirstlane_b32 s70, v12
    s_nop 0
    s_cmp_ge_u32 s70, 4
    s_cbranch_scc1 L_lwd_2
    s_add_u32 s68, s68, 1
    s_cmp_lt_u32 s68, 0x200000
    s_cbranch_scc1 L_lw_1
L_lwd_2:
    s_bfe_u32 s79, s18, 0x40008
    s_mul_i32 s79, s79, 98304
    s_add_u32 s79, s79, s3
    s_add_u32 m0, s78, 8192
    s_nop 0
    buffer_load_dwordx4 v4, s[44:47], s79 offen offset:0 lds
    buffer_load_dwordx4 v5, s[44:47], s79 offen offset:1024 lds
    buffer_load_dwordx4 v6, s[44:47], s79 offen offset:2048 lds
    buffer_load_dwordx4 v7, s[44:47], s79 offen offset:3072 lds
    s_bfe_u32 s79, s18, 0x4000c
    s_mul_i32 s79, s79, 98304
    s_add_u32 s79, s79, s3
    s_add_u32 m0, s78, 12288
    s_nop 0
    buffer_load_dwordx4 v4, s[44:47], s79 offen offset:0 lds
    buffer_load_dwordx4 v5, s[44:47], s79 offen offset:1024 lds
    buffer_load_dwordx4 v6, s[44:47], s79 offen offset:2048 lds
    buffer_load_dwordx4 v7, s[44:47], s79 offen offset:3072 lds
    s_bfe_u32 s79, s18, 0x40010
    s_mul_i32 s79, s79, 98304
    s_add_u32 s79, s79, s3
    s_add_u32 m0, s78, 16384
    s_nop 0
    buffer_load_dwordx4 v4, s[44:47], s79 offen offset:0 lds
    buffer_load_dwordx4 v5, s[44:47], s79 offen offset:1024 lds
    buffer_load_dwordx4 v6, s[44:47], s79 offen offset:2048 lds
    buffer_load_dwordx4 v7, s[44:47], s79 offen offset:3072 lds
    s_bfe_u32 s79, s18, 0x40014
    s_mul_i32 s79, s79, 98304
    s_add_u32 s79, s79, s3
    s_add_u32 m0, s78, 20480
    s_nop 0
    buffer_load_dwordx4 v4, s[44:47], s79 offen offset:0 lds
    buffer_load_dwordx4 v5, s[44:47], s79 offen offset:1024 lds
    buffer_load_dwordx4 v6, s[44:47], s79 offen offset:2048 lds
    buffer_load_dwordx4 v7, s[44:47], s79 offen offset:3072 lds
    s_bfe_u32 s79, s18, 0x40018
    s_mul_i32 s79, s79, 98304
    s_add_u32 s79, s79, s3
    s_add_u32 m0, s78, 24576
    s_nop 0
    buffer_load_dwordx4 v4, s[44:47], s79 offen offset:0 lds
    buffer_load_dwordx4 v5, s[44:47], s79 offen offset:1024 lds
    buffer_load_dwordx4 v6, s[44:47], s79 offen offset:2048 lds
    buffer_load_dwordx4 v7, s[44:47], s79 offen offset:3072 lds
    s_waitcnt vmcnt(27)
    ds_read_b64_tr_b16 v[252:253], v8 offset:0
    ds_read_b64_tr_b16 v[254:255], v8 offset:512
    ds_read_b64_tr_b16 v[248:249], v9 offset:0
    ds_read_b64_tr_b16 v[250:251], v9 offset:512
    ds_read_b64_tr_b16 v[244:245], v10 offset:0
    ds_read_b64_tr_b16 v[246:247], v10 offset:512
    ds_read_b64_tr_b16 v[240:241], v11 offset:0
    ds_read_b64_tr_b16 v[242:243], v11 offset:512
    s_waitcnt lgkmcnt(0)
    s_bfe_u32 s79, s18, 0x4001c
    s_mul_i32 s79, s79, 98304
    s_add_u32 s79, s79, s3
    s_add_u32 m0, s78, 0
    s_nop 0
    buffer_load_dwordx4 v4, s[44:47], s79 offen offset:0 lds
    buffer_load_dwordx4 v5, s[44:47], s79 offen offset:1024 lds
    buffer_load_dwordx4 v6, s[44:47], s79 offen offset:2048 lds
    buffer_load_dwordx4 v7, s[44:47], s79 offen offset:3072 lds
    s_waitcnt vmcnt(27)
    ds_read_b64_tr_b16 v[236:237], v8 offset:4096
    ds_read_b64_tr_b16 v[238:239], v8 offset:4608
    ds_read_b64_tr_b16 v[232:233], v9 offset:4096
    ds_read_b64_tr_b16 v[234:235], v9 offset:4608
    ds_read_b64_tr_b16 v[228:229], v10 offset:4096
    ds_read_b64_tr_b16 v[230:231], v10 offset:4608
    ds_read_b64_tr_b16 v[224:225], v11 offset:4096
    ds_read_b64_tr_b16 v[226:227], v11 offset:4608
    s_waitcnt lgkmcnt(0)
    s_bfe_u32 s79, s19, 0x40000
    s_mul_i32 s79, s79, 98304
    s_add_u32 s79, s79, s3
    s_add_u32 m0, s78, 4096
    s_nop 0
    buffer_load_dwordx4 v4, s[44:47], s79 offen offset:0 lds
    buffer_load_dwordx4 v5, s[44:47], s79 offen offset:1024 lds
    buffer_load_dwordx4 v6, s[44:47], s79 offen offset:2048 lds
    buffer_load_dwordx4 v7, s[44:47], s79 offen offset:3072 lds
    s_waitcnt vmcnt(24)
    ds_read_b64_tr_b16 v[220:221], v8 offset:8192
    ds_read_b64_tr_b16 v[222:223], v8 offset:8704
    ds_read_b64_tr_b16 v[216:217], v9 offset:8192
    ds_read_b64_tr_b16 v[218:219], v9 offset:8704
    ds_read_b64_tr_b16 v[212:213], v10 offset:8192
    ds_read_b64_tr_b16 v[214:215], v10 offset:8704
    ds_read_b64_tr_b16 v[208:209], v11 offset:8192
    ds_read_b64_tr_b16 v[210:211], v11 offset:8704
    s_waitcnt lgkmcnt(0)
    s_bfe_u32 s79, s19, 0x40004
    s_mul_i32 s79, s79, 98304
    s_add_u32 s79, s79, s3
    s_add_u32 m0, s78, 8192
    s_nop 0
    buffer_load_dwordx4 v4, s[44:47], s79 offen offset:0 lds
    buffer_load_dwordx4 v5, s[44:47], s79 offen offset:1024 lds
    buffer_load_dwordx4 v6, s[44:47], s79 offen offset:2048 lds
    buffer_load_dwordx4 v7, s[44:47], s79 offen offset:3072 lds
    s_waitcnt vmcnt(24)
    ds_read_b64_tr_b16 v[204:205], v8 offset:12288
    ds_read_b64_tr_b16 v[206:207], v8 offset:12800
    ds_read_b64_tr_b16 v[200:201], v9 offset:12288
    ds_read_b64_tr_b16 v[202:203], v9 offset:12800
    ds_read_b64_tr_b16 v[196:197], v10 offset:12288
    ds_read_b64_tr_b16 v[198:199], v10 offset:12800
    ds_read_b64_tr_b16 v[192:193], v11 offset:12288
    ds_read_b64_tr_b16 v[194:195], v11 offset:12800
    s_waitcnt lgkmcnt(0)
    s_bfe_u32 s79, s19, 0x40008
    s_mul_i32 s79, s79, 98304
    s_add_u32 s79, s79, s3
    s_add_u32 m0, s78, 12288
    s_nop 0
    buffer_load_dwordx4 v4, s[44:47], s79 offen offset:0 lds
    buffer_load_dwordx4 v5, s[44:47], s79 offen offset:1024 lds
    buffer_load_dwordx4 v6, s[44:47], s79 offen offset:2048 lds
    buffer_load_dwordx4 v7, s[44:47], s79 offen offset:3072 lds
    s_waitcnt vmcnt(24)
    ds_read_b64_tr_b16 v[188:189], v8 offset:16384
    ds_read_b64_tr_b16 v[190:191], v8 offset:16896
    ds_read_b64_tr_b16 v[184:185], v9 offset:16384
    ds_read_b64_tr_b16 v[186:187], v9 offset:16896
    ds_read_b64_tr_b16 v[180:181], v10 offset:16384
    ds_read_b64_tr_b16 v[182:183], v10 offset:16896
    ds_read_b64_tr_b16 v[176:177], v11 offset:16384
    ds_read_b64_tr_b16 v[178:179], v11 offset:16896
    s_waitcnt lgkmcnt(0)
    s_bfe_u32 s79, s19, 0x4000c
    s_mul_i32 s79, s79, 98304
    s_add_u32 s79, s79, s3
    s_add_u32 m0, s78, 16384
    s_nop 0
    buffer_load_dwordx4 v4, s[44:47], s79 offen offset:0 lds
    buffer_load_dwordx4 v5, s[44:47], s79 offen offset:1024 lds
    buffer_load_dwordx4 v6, s[44:47], s79 offen offset:2048 lds
    buffer_load_dwordx4 v7, s[44:47], s79 offen offset:3072 lds
    s_waitcnt vmcnt(24)
    ds_read_b64_tr_b16 v[172:173], v8 offset:20480
    ds_read_b64_tr_b16 v[174:175], v8 offset:20992
    ds_read_b64_tr_b16 v[168:169], v9 offset:20480
    ds_read_b64_tr_b16 v[170:171], v9 offset:20992
    ds_read_b64_tr_b16 v[164:165], v10 offset:20480
    ds_read_b64_tr_b16 v[166:167], v10 offset:20992
    ds_read_b64_tr_b16 v[160:161], v11 offset:20480
    ds_read_b64_tr_b16 v[162:163], v11 offset:20992
    s_waitcnt lgkmcnt(0)
    s_bfe_u32 s79, s19, 0x40010
    s_mul_i32 s79, s79, 98304
    s_add_u32 s79, s79, s3
    s_add_u32 m0, s78, 20480
    s_nop 0
    buffer_load_dwordx4 v4, s[44:47], s79 offen offset:0 lds
    buffer_load_dwordx4 v5, s[44:47], s79 offen offset:1024 lds
    buffer_load_dwordx4 v6, s[44:47], s79 offen offset:2048 lds
    buffer_load_dwordx4 v7, s[44:47], s79 offen offset:3072 lds
    s_waitcnt vmcnt(24)
    ds_read_b64_tr_b16 v[156:157], v8 offset:24576
    ds_read_b64_tr_b16 v[158:159], v8 offset:25088
    ds_read_b64_tr_b16 v[152:153], v9 offset:24576
    ds_read_b64_tr_b16 v[154:155], v9 offset:25088
    ds_read_b64_tr_b16 v[148:149], v10 offset:24576
    ds_read_b64_tr_b16 v[150:151], v10 offset:25088
    ds_read_b64_tr_b16 v[144:145], v11 offset:24576
    ds_read_b64_tr_b16 v[146:147], v11 offset:25088
    s_waitcnt lgkmcnt(0)
    s_bfe_u32 s79, s19, 0x40014
    s_mul_i32 s79, s79, 98304
    s_add_u32 s79, s79, s3
    s_add_u32 m0, s78, 24576
    s_nop 0
    buffer_load_dwordx4 v4, s[44:47], s79 offen offset:0 lds
    buffer_load_dwordx4 v5, s[44:47], s79 offen offset:1024 lds
    buffer_load_dwordx4 v6, s[44:47], s79 offen offset:2048 lds
    buffer_load_dwordx4 v7, s[44:47], s79 offen offset:3072 lds
    s_and_b32 s70, s60, 3
    s_lshl_b32 s70, s70, 2
    s_add_u32 s70, s70, s59
    s_mul_i32 s70, s70, 1024
    s_add_u32 s70, s70, 0x10000
    v_mul_u32_u24_e64 v12, 16, v0
    s_lshl_b32 s74, s60, 18
    s_lshl_b32 s75, s59, 16
    s_add_u32 s74, s74, s75
    s_add_u32 s69, s74, 0x100000
    s_bfe_u32 s74, s18, 0x40000
    s_mul_i32 s74, s74, 4096
    s_add_u32 s74, s74, s69
    buffer_load_dwordx2 v[14:15], v12, s[40:43], s70 offen sc1
    s_waitcnt vmcnt(25)
    ds_read_b64_tr_b16 v[140:141], v8 offset:0
    ds_read_b64_tr_b16 v[142:143], v8 offset:512
    ds_read_b64_tr_b16 v[136:137], v9 offset:0
    ds_read_b64_tr_b16 v[138:139], v9 offset:512
    ds_read_b64_tr_b16 v[132:133], v10 offset:0
    ds_read_b64_tr_b16 v[134:135], v10 offset:512
    ds_read_b64_tr_b16 v[128:129], v11 offset:0
    ds_read_b64_tr_b16 v[130:131], v11 offset:512
    s_waitcnt lgkmcnt(0)
    s_bfe_u32 s79, s19, 0x40018
    s_mul_i32 s79, s79, 98304
    s_add_u32 s79, s79, s3
    s_add_u32 m0, s78, 0
    s_nop 0
    buffer_load_dwordx4 v4, s[44:47], s79 offen offset:0 lds
    buffer_load_dwordx4 v5, s[44:47], s79 offen offset:1024 lds
    buffer_load_dwordx4 v6, s[44:47], s79 offen offset:2048 lds
    buffer_load_dwordx4 v7, s[44:47], s79 offen offset:3072 lds
    s_waitcnt vmcnt(25)
    ds_read_b64_tr_b16 v[124:125], v8 offset:4096
    ds_read_b64_tr_b16 v[126:127], v8 offset:4608
    ds_read_b64_tr_b16 v[120:121], v9 offset:4096
    ds_read_b64_tr_b16 v[122:123], v9 offset:4608
    ds_read_b64_tr_b16 v[116:117], v10 offset:4096
    ds_read_b64_tr_b16 v[118:119], v10 offset:4608
    ds_read_b64_tr_b16 v[112:113], v11 offset:4096
    ds_read_b64_tr_b16 v[114:115], v11 offset:4608
    s_waitcnt lgkmcnt(0)
    s_bfe_u32 s79, s19, 0x4001c
    s_mul_i32 s79, s79, 98304
    s_add_u32 s79, s79, s3
    s_add_u32 m0, s78, 4096
    s_nop 0
    buffer_load_dwordx4 v4, s[44:47], s79 offen offset:0 lds
    buffer_load_dwordx4 v5, s[44:47], s79 offen offset:1024 lds
    buffer_load_dwordx4 v6, s[44:47], s79 offen offset:2048 lds
    buffer_load_dwordx4 v7, s[44:47], s79 offen offset:3072 lds
    s_waitcnt vmcnt(8)
    v_cmp_ne_u64 vcc, s[56:57], v[14:15]
    s_cbranch_vccz L_pf_3
    s_mov_b32 s68, 0
L_pl_4:
    buffer_load_dwordx2 v[14:15], v12, s[40:43], s70 offen sc1
    s_waitcnt vmcnt(0)
    v_cmp_ne_u64_e64 vcc, s[56:57], v[14:15]
    s_nop 0
    s_and_b64 exec, exec, vcc
    s_cbranch_scc0 L_pld_5
    s_sleep 1
    s_add_u32 s68, s68, 1
    s_cmp_lt_u32 s68, 0x40000
    s_cbranch_scc1 L_pl_4
L_pld_5:
    s_mov_b64 exec, -1
L_pf_3:
    buffer_load_dwordx4 v[80:83], v2, s[40:43], s74 offen offset:0 sc1
    buffer_load_dwordx4 v[84:87], v2, s[40:43], s74 offen offset:1024 sc1
    buffer_load_dwordx4 v[88:91], v2, s[40:43], s74 offen offset:2048 sc1
    buffer_load_dwordx4 v[92:95], v2, s[40:43], s74 offen offset:3072 sc1
    s_bfe_u32 s74, s18, 0x40004
    s_mul_i32 s74, s74, 4096
    s_add_u32 s74, s74, s69
    buffer_load_dwordx4 v[96:99], v2, s[40:43], s74 offen offset:0 sc1
    buffer_load_dwordx4 v[100:103], v2, s[40:43], s74 offen offset:1024 sc1
    buffer_load_dwordx4 v[104:107], v2, s[40:43], s74 offen offset:2048 sc1
    buffer_load_dwordx4 v[108:111], v2, s[40:43], s74 offen offset:3072 sc1
    s_mov_b64 exec, 1
    ds_add_u32 v1, v3 offset:0
    s_mov_b64 exec, -1
    s_waitcnt vmcnt(7)
    v_mfma_f32_16x16x32_bf16 v[12:15], v[252:255], v[80:83], 0
    v_mfma_f32_16x16x32_bf16 v[32:35], v[248:251], v[80:83], 0
    v_mfma_f32_16x16x32_bf16 v[48:51], v[244:247], v[80:83], 0
    v_mfma_f32_16x16x32_bf16 v[64:67], v[240:243], v[80:83], 0
    s_waitcnt vmcnt(6)
    v_mfma_f32_16x16x32_bf16 v[16:19], v[252:255], v[84:87], 0
    s_bfe_u32 s74, s18, 0x40008
    s_mul_i32 s74, s74, 4096
    v_mfma_f32_16x16x32_bf16 v[36:39], v[248:251], v[84:87], 0
    s_add_u32 s74, s74, s69
    buffer_load_dwordx4 v[20:23], v2, s[40:43], s74 offen offset:0 sc1
    v_mfma_f32_16x16x32_bf16 v[52:55], v[244:247], v[84:87], 0
    v_mfma_f32_16x16x32_bf16 v[68:71], v[240:243], v[84:87], 0
    s_waitcnt vmcnt(6)
    v_mfma_f32_16x16x32_bf16 v[24:27], v[252:255], v[88:91], 0
    buffer_load_dwordx4 v[80:83], v2, s[40:43], s74 offen offset:1024 sc1
    v_mfma_f32_16x16x32_bf16 v[40:43], v[248:251], v[88:91], 0
    v_mfma_f32_16x16x32_bf16 v[56:59], v[244:247], v[88:91], 0
    v_mfma_f32_16x16x32_bf16 v[72:75], v[240:243], v[88:91], 0
    s_waitcnt vmcnt(6)
    v_mfma_f32_16x16x32_bf16 v[28:31], v[252:255], v[92:95], 0
    buffer_load_dwordx4 v[84:87], v2, s[40:43], s74 offen offset:2048 sc1
    v_mfma_f32_16x16x32_bf16 v[44:47], v[248:251], v[92:95], 0
    v_mfma_f32_16x16x32_bf16 v[60:63], v[244:247], v[92:95], 0
    v_mfma_f32_16x16x32_bf16 v[76:79], v[240:243], v[92:95], 0
    s_waitcnt vmcnt(6)
    v_mfma_f32_16x16x32_bf16 v[12:15], v[236:239], v[96:99], v[12:15]
    buffer_load_dwordx4 v[88:91], v2, s[40:43], s74 offen offset:3072 sc1
    v_mfma_f32_16x16x32_bf16 v[32:35], v[232:235], v[96:99], v[32:35]
    ds_read_b64_tr_b16 v[92:93], v8 offset:8192
    ds_read_b64_tr_b16 v[94:95], v8 offset:8704
    v_mfma_f32_16x16x32_bf16 v[48:51], v[228:231], v[96:99], v[48:51]
    ds_read_b64_tr_b16 v[252:253], v9 offset:8192
    ds_read_b64_tr_b16 v[254:255], v9 offset:8704
    v_mfma_f32_16x16x32_bf16 v[64:67], v[224:227], v[96:99], v[64:67]
    ds_read_b64_tr_b16 v[248:249], v10 offset:8192
    ds_read_b64_tr_b16 v[250:251], v10 offset:8704
    s_waitcnt vmcnt(6)
    v_mfma_f32_16x16x32_bf16 v[16:19], v[236:239], v[100:103], v[16:19]
    s_bfe_u32 s74, s18, 0x4000c
    s_mul_i32 s74, s74, 4096
    v_mfma_f32_16x16x32_bf16 v[36:39], v[232:235], v[100:103], v[36:39]
    s_add_u32 s74, s74, s69
    buffer_load_dwordx4 v[240:243], v2, s[40:43], s74 offen offset:0 sc1
    v_mfma_f32_16x16x32_bf16 v[52:55], v[228:231], v[100:103], v[52:55]
    ds_read_b64_tr_b16 v[244:245], v11 offset:8192
    ds_read_b64_tr_b16 v[246:247], v11 offset:8704
    v_mfma_f32_16x16x32_bf16 v[68:71], v[224:227], v[100:103], v[68:71]
    s_waitcnt vmcnt(6)
    v_mfma_f32_16x16x32_bf16 v[24:27], v[236:239], v[104:107], v[24:27]
    buffer_load_dwordx4 v[96:99], v2, s[40:43], s74 offen offset:1024 sc1
    v_mfma_f32_16x16x32_bf16 v[40:43], v[232:235], v[104:107], v[40:43]
    v_mfma_f32_16x16x32_bf16 v[56:59], v[228:231], v[104:107], v[56:59]
    v_mfma_f32_16x16x32_bf16 v[72:75], v[224:227], v[104:107], v[72:75]
    s_waitcnt vmcnt(6)
    v_mfma_f32_16x16x32_bf16 v[28:31], v[236:239], v[108:111], v[28:31]
    buffer_load_dwordx4 v[100:103], v2, s[40:43], s74 offen offset:2048 sc1
    v_mfma_f32_16x16x32_bf16 v[44:47], v[232:235], v[108:111], v[44:47]
    v_mfma_f32_16x16x32_bf16 v[60:63], v[228:231], v[108:111], v[60:63]
    v_mfma_f32_16x16x32_bf16 v[76:79], v[224:227], v[108:111], v[76:79]
    s_waitcnt vmcnt(6)
    v_mfma_f32_16x16x32_bf16 v[12:15], v[220:223], v[20:23], v[12:15]
    buffer_load_dwordx4 v[104:107], v2, s[40:43], s74 offen offset:3072 sc1
    v_mfma_f32_16x16x32_bf16 v[32:35], v[216:219], v[20:23], v[32:35]
    ds_read_b64_tr_b16 v[108:109], v8 offset:12288
    ds_read_b64_tr_b16 v[110:111], v8 offset:12800
    v_mfma_f32_16x16x32_bf16 v[48:51], v[212:215], v[20:23], v[48:51]
    ds_read_b64_tr_b16 v[236:237], v9 offset:12288
    ds_read_b64_tr_b16 v[238:239], v9 offset:12800
    v_mfma_f32_16x16x32_bf16 v[64:67], v[208:211], v[20:23], v[64:67]
    ds_read_b64_tr_b16 v[232:233], v10 offset:12288
    ds_read_b64_tr_b16 v[234:235], v10 offset:12800
    s_waitcnt vmcnt(6)
    v_mfma_f32_16x16x32_bf16 v[16:19], v[220:223], v[80:83], v[16:19]
    s_bfe_u32 s74, s18, 0x40010
    s_mul_i32 s74, s74, 4096
    v_mfma_f32_16x16x32_bf16 v[36:39], v[216:219], v[80:83], v[36:39]
    s_add_u32 s74, s74, s69
    buffer_load_dwordx4 v[224:227], v2, s[40:43], s74 offen offset:0 sc1
    v_mfma_f32_16x16x32_bf16 v[52:55], v[212:215], v[80:83], v[52:55]
    ds_read_b64_tr_b16 v[228:229], v11 offset:12288
    ds_read_b64_tr_b16 v[230:231], v11 offset:12800
    v_mfma_f32_16x16x32_bf16 v[68:71], v[208:211], v[80:83], v[68:71]
    s_waitcnt vmcnt(6)
    v_mfma_f32_16x16x32_bf16 v[24:27], v[220:223], v[84:87], v[24:27]
    buffer_load_dwordx4 v[20:23], v2, s[40:43], s74 offen offset:1024 sc1
    v_mfma_f32_16x16x32_bf16 v[40:43], v[216:219], v[84:87], v[40:43]
    v_mfma_f32_16x16x32_bf16 v[56:59], v[212:215], v[84:87], v[56:59]
    v_mfma_f32_16x16x32_bf16 v[72:75], v[208:211], v[84:87], v[72:75]
    s_waitcnt vmcnt(6)
    v_mfma_f32_16x16x32_bf16 v[28:31], v[220:223], v[88:91], v[28:31]
    buffer_load_dwordx4 v[80:83], v2, s[40:43], s74 offen offset:2048 sc1
    v_mfma_f32_16x16x32_bf16 v[44:47], v[216:219], v[88:91], v[44:47]
    v_mfma_f32_16x16x32_bf16 v[60:63], v[212:215], v[88:91], v[60:63]
    v_mfma_f32_16x16x32_bf16 v[76:79], v[208:211], v[88:91], v[76:79]
    s_waitcnt vmcnt(6)
    v_mfma_f32_16x16x32_bf16 v[12:15], v[204:207], v[240:243], v[12:15]
    buffer_load_dwordx4 v[84:87], v2, s[40:43], s74 offen offset:3072 sc1
    v_mfma_f32_16x16x32_bf16 v[32:35], v[200:203], v[240:243], v[32:35]
    ds_read_b64_tr_b16 v[88:89], v8 offset:16384
    ds_read_b64_tr_b16 v[90:91], v8 offset:16896
    v_mfma_f32_16x16x32_bf16 v[48:51], v[196:199], v[240:243], v[48:51]
    ds_read_b64_tr_b16 v[220:221], v9 offset:16384
    ds_read_b64_tr_b16 v[222:223], v9 offset:16896
    v_mfma_f32_16x16x32_bf16 v[64:67], v[192:195], v[240:243], v[64:67]
    ds_read_b64_tr_b16 v[216:217], v10 offset:16384
    ds_read_b64_tr_b16 v[218:219], v10 offset:16896
    s_waitcnt vmcnt(6)
    v_mfma_f32_16x16x32_bf16 v[16:19], v[204:207], v[96:99], v[16:19]
    s_bfe_u32 s74, s18, 0x40014
    s_mul_i32 s74, s74, 4096
    v_mfma_f32_16x16x32_bf16 v[36:39], v[200:203], v[96:99], v[36:39]
    s_add_u32 s74, s74, s69
    buffer_load_dwordx4 v[208:211], v2, s[40:43], s74 offen offset:0 sc1
    v_mfma_f32_16x16x32_bf16 v[52:55], v[196:199], v[96:99], v[52:55]
    ds_read_b64_tr_b16 v[212:213], v11 offset:16384
    ds_read_b64_tr_b16 v[214:215], v11 offset:16896
    v_mfma_f32_16x16x32_bf16 v[68:71], v[192:195], v[96:99], v[68:71]
    s_waitcnt vmcnt(6)
    v_mfma_f32_16x16x32_bf16 v[24:27], v[204:207], v[100:103], v[24:27]
    buffer_load_dwordx4 v[240:243], v2, s[40:43], s74 offen offset:1024 sc1
    v_mfma_f32_16x16x32_bf16 v[40:43], v[200:203], v[100:103], v[40:43]
    v_mfma_f32_16x16x32_bf16 v[56:59], v[196:199], v[100:103], v[56:59]
    v_mfma_f32_16x16x32_bf16 v[72:75], v[192:195], v[100:103], v[72:75]
    s_waitcnt vmcnt(6)
    v_mfma_f32_16x16x32_bf16 v[28:31], v[204:207], v[104:107], v[28:31]
    buffer_load_dwordx4 v[96:99], v2, s[40:43], s74 offen offset:2048 sc1
    v_mfma_f32_16x16x32_bf16 v[44:47], v[200:203], v[104:107], v[44:47]
    v_mfma_f32_16x16x32_bf16 v[60:63], v[196:199], v[104:107], v[60:63]
    v_mfma_f32_16x16x32_bf16 v[76:79], v[192:195], v[104:107], v[76:79]
    s_waitcnt vmcnt(6)
    v_mfma_f32_16x16x32_bf16 v[12:15], v[188:191], v[224:227], v[12:15]
    buffer_load_dwordx4 v[100:103], v2, s[40:43], s74 offen offset:3072 sc1
    v_mfma_f32_16x16x32_bf16 v[32:35], v[184:187], v[224:227], v[32:35]
    ds_read_b64_tr_b16 v[104:105], v8 offset:20480
    ds_read_b64_tr_b16 v[106:107], v8 offset:20992
    v_mfma_f32_16x16x32_bf16 v[48:51], v[180:183], v[224:227], v[48:51]
    ds_read_b64_tr_b16 v[204:205], v9 offset:20480
    ds_read_b64_tr_b16 v[206:207], v9 offset:20992
    v_mfma_f32_16x16x32_bf16 v[64:67], v[176:179], v[224:227], v[64:67]
    ds_read_b64_tr_b16 v[200:201], v10 offset:20480
    ds_read_b64_tr_b16 v[202:203], v10 offset:20992
    s_waitcnt vmcnt(6)
    v_mfma_f32_16x16x32_bf16 v[16:19], v[188:191], v[20:23], v[16:19]
    s_bfe_u32 s74, s18, 0x40018
    s_mul_i32 s74, s74, 4096
    v_mfma_f32_16x16x32_bf16 v[36:39], v[184:187], v[20:23], v[36:39]
    s_add_u32 s74, s74, s69
    buffer_load_dwordx4 v[192:195], v2, s[40:43], s74 offen offset:0 sc1
    v_mfma_f32_16x16x32_bf16 v[52:55], v[180:183], v[20:23], v[52:55]
    ds_read_b64_tr_b16 v[196:197], v11 offset:20480
    ds_read_b64_tr_b16 v[198:199], v11 offset:20992
    v_mfma_f32_16x16x32_bf16 v[68:71], v[176:179], v[20:23], v[68:71]
    s_waitcnt vmcnt(6)
    v_mfma_f32_16x16x32_bf16 v[24:27], v[188:191], v[80:83], v[24:27]
    buffer_load_dwordx4 v[224:227], v2, s[40:43], s74 offen offset:1024 sc1
    v_mfma_f32_16x16x32_bf16 v[40:43], v[184:187], v[80:83], v[40:43]
    v_mfma_f32_16x16x32_bf16 v[56:59], v[180:183], v[80:83], v[56:59]
    v_mfma_f32_16x16x32_bf16 v[72:75], v[176:179], v[80:83], v[72:75]
    s_waitcnt vmcnt(6)
    v_mfma_f32_16x16x32_bf16 v[28:31], v[188:191], v[84:87], v[28:31]
    buffer_load_dwordx4 v[20:23], v2, s[40:43], s74 offen offset:2048 sc1
    v_mfma_f32_16x16x32_bf16 v[44:47], v[184:187], v[84:87], v[44:47]
    v_mfma_f32_16x16x32_bf16 v[60:63], v[180:183], v[84:87], v[60:63]
    v_mfma_f32_16x16x32_bf16 v[76:79], v[176:179], v[84:87], v[76:79]
    s_waitcnt vmcnt(6)
    v_mfma_f32_16x16x32_bf16 v[12:15], v[172:175], v[208:211], v[12:15]
    buffer_load_dwordx4 v[80:83], v2, s[40:43], s74 offen offset:3072 sc1
    v_mfma_f32_16x16x32_bf16 v[32:35], v[168:171], v[208:211], v[32:35]
    ds_read_b64_tr_b16 v[84:85], v8 offset:24576
    ds_read_b64_tr_b16 v[86:87], v8 offset:25088
    v_mfma_f32_16x16x32_bf16 v[48:51], v[164:167], v[208:211], v[48:51]
    ds_read_b64_tr_b16 v[188:189], v9 offset:24576
    ds_read_b64_tr_b16 v[190:191], v9 offset:25088
    v_mfma_f32_16x16x32_bf16 v[64:67], v[160:163], v[208:211], v[64:67]
    ds_read_b64_tr_b16 v[184:185], v10 offset:24576
    ds_read_b64_tr_b16 v[186:187], v10 offset:25088
    s_waitcnt vmcnt(6)
    v_mfma_f32_16x16x32_bf16 v[16:19], v[172:175], v[240:243], v[16:19]
    s_bfe_u32 s74, s18, 0x4001c
    s_mul_i32 s74, s74, 4096
    v_mfma_f32_16x16x32_bf16 v[36:39], v[168:171], v[240:243], v[36:39]
    s_add_u32 s74, s74, s69
    buffer_load_dwordx4 v[176:179], v2, s[40:43], s74 offen offset:0 sc1
    v_mfma_f32_16x16x32_bf16 v[52:55], v[164:167], v[240:243], v[52:55]
    ds_read_b64_tr_b16 v[180:181], v11 offset:24576
    ds_read_b64_tr_b16 v[182:183], v11 offset:25088
    v_mfma_f32_16x16x32_bf16 v[68:71], v[160:163], v[240:243], v[68:71]
    s_waitcnt vmcnt(6)
    v_mfma_f32_16x16x32_bf16 v[24:27], v[172:175], v[96:99], v[24:27]
    buffer_load_dwordx4 v[208:211], v2, s[40:43], s74 offen offset:1024 sc1
    v_mfma_f32_16x16x32_bf16 v[40:43], v[168:171], v[96:99], v[40:43]
    v_mfma_f32_16x16x32_bf16 v[56:59], v[164:167], v[96:99], v[56:59]
    v_mfma_f32_16x16x32_bf16 v[72:75], v[160:163], v[96:99], v[72:75]
    s_waitcnt vmcnt(6)
    v_mfma_f32_16x16x32_bf16 v[28:31], v[172:175], v[100:103], v[28:31]
    buffer_load_dwordx4 v[240:243], v2, s[40:43], s74 offen offset:2048 sc1
    v_mfma_f32_16x16x32_bf16 v[44:47], v[168:171], v[100:103], v[44:47]
    v_mfma_f32_16x16x32_bf16 v[60:63], v[164:167], v[100:103], v[60:63]
    v_mfma_f32_16x16x32_bf16 v[76:79], v[160:163], v[100:103], v[76:79]
    s_waitcnt vmcnt(6)
    v_mfma_f32_16x16x32_bf16 v[12:15], v[156:159], v[192:195], v[12:15]
    buffer_load_dwordx4 v[96:99], v2, s[40:43], s74 offen offset:3072 sc1
    v_mfma_f32_16x16x32_bf16 v[32:35], v[152:155], v[192:195], v[32:35]
    ds_read_b64_tr_b16 v[100:101], v8 offset:0
    ds_read_b64_tr_b16 v[102:103], v8 offset:512
    v_mfma_f32_16x16x32_bf16 v[48:51], v[148:151], v[192:195], v[48:51]
    ds_read_b64_tr_b16 v[172:173], v9 offset:0
    ds_read_b64_tr_b16 v[174:175], v9 offset:512
    v_mfma_f32_16x16x32_bf16 v[64:67], v[144:147], v[192:195], v[64:67]
    ds_read_b64_tr_b16 v[168:169], v10 offset:0
    ds_read_b64_tr_b16 v[170:171], v10 offset:512
    s_waitcnt vmcnt(6)
    v_mfma_f32_16x16x32_bf16 v[16:19], v[156:159], v[224:227], v[16:19]
    s_bfe_u32 s74, s19, 0x40000
    s_mul_i32 s74, s74, 4096
    v_mfma_f32_16x16x32_bf16 v[36:39], v[152:155], v[224:227], v[36:39]
    s_add_u32 s74, s74, s69
    buffer_load_dwordx4 v[160:163], v2, s[40:43], s74 offen offset:0 sc1
    v_mfma_f32_16x16x32_bf16 v[52:55], v[148:151], v[224:227], v[52:55]
    ds_read_b64_tr_b16 v[164:165], v11 offset:0
    ds_read_b64_tr_b16 v[166:167], v11 offset:512
    v_mfma_f32_16x16x32_bf16 v[68:71], v[144:147], v[224:227], v[68:71]
    s_waitcnt vmcnt(6)
    v_mfma_f32_16x16x32_bf16 v[24:27], v[156:159], v[20:23], v[24:27]
    buffer_load_dwordx4 v[192:195], v2, s[40:43], s74 offen offset:1024 sc1
    v_mfma_f32_16x16x32_bf16 v[40:43], v[152:155], v[20:23], v[40:43]
    v_mfma_f32_16x16x32_bf16 v[56:59], v[148:151], v[20:23], v[56:59]
    v_mfma_f32_16x16x32_bf16 v[72:75], v[144:147], v[20:23], v[72:75]
    s_waitcnt vmcnt(6)
    v_mfma_f32_16x16x32_bf16 v[28:31], v[156:159], v[80:83], v[28:31]
    buffer_load_dwordx4 v[224:227], v2, s[40:43], s74 offen offset:2048 sc1
    v_mfma_f32_16x16x32_bf16 v[44:47], v[152:155], v[80:83], v[44:47]
    v_mfma_f32_16x16x32_bf16 v[60:63], v[148:151], v[80:83], v[60:63]
    v_mfma_f32_16x16x32_bf16 v[76:79], v[144:147], v[80:83], v[76:79]
    s_waitcnt vmcnt(6)
    v_mfma_f32_16x16x32_bf16 v[12:15], v[140:143], v[176:179], v[12:15]
    buffer_load_dwordx4 v[20:23], v2, s[40:43], s74 offen offset:3072 sc1
    v_mfma_f32_16x16x32_bf16 v[32:35], v[136:139], v[176:179], v[32:35]
    ds_read_b64_tr_b16 v[80:81], v8 offset:4096
    ds_read_b64_tr_b16 v[82:83], v8 offset:4608
    v_mfma_f32_16x16x32_bf16 v[48:51], v[132:135], v[176:179], v[48:51]
    ds_read_b64_tr_b16 v[156:157], v9 offset:4096
    ds_read_b64_tr_b16 v[158:159], v9 offset:4608
    v_mfma_f32_16x16x32_bf16 v[64:67], v[128:131], v[176:179], v[64:67]
    ds_read_b64_tr_b16 v[152:153], v10 offset:4096
    ds_read_b64_tr_b16 v[154:155], v10 offset:4608
    s_waitcnt vmcnt(6)
    v_mfma_f32_16x16x32_bf16 v[16:19], v[140:143], v[208:211], v[16:19]
    s_bfe_u32 s74, s19, 0x40004
    s_mul_i32 s74, s74, 4096
    v_mfma_f32_16x16x32_bf16 v[36:39], v[136:139], v[208:211], v[36:39]
    s_add_u32 s74, s74, s69
    buffer_load_dwordx4 v[144:147], v2, s[40:43], s74 offen offset:0 sc1
    v_mfma_f32_16x16x32_bf16 v[52:55], v[132:135], v[208:211], v[52:55]
    ds_read_b64_tr_b16 v[148:149], v11 offset:4096
    ds_read_b64_tr_b16 v[150:151], v11 offset:4608
    v_mfma_f32_16x16x32_bf16 v[68:71], v[128:131], v[208:211], v[68:71]
    s_waitcnt vmcnt(6)
    v_mfma_f32_16x16x32_bf16 v[24:27], v[140:143], v[240:243], v[24:27]
    buffer_load_dwordx4 v[176:179], v2, s[40:43], s74 offen offset:1024 sc1
    v_mfma_f32_16x16x32_bf16 v[40:43], v[136:139], v[240:243], v[40:43]
    v_mfma_f32_16x16x32_bf16 v[56:59], v[132:135], v[240:243], v[56:59]
    v_mfma_f32_16x16x32_bf16 v[72:75], v[128:131], v[240:243], v[72:75]
    s_waitcnt vmcnt(6)
    v_mfma_f32_16x16x32_bf16 v[28:31], v[140:143], v[96:99], v[28:31]
    buffer_load_dwordx4 v[208:211], v2, s[40:43], s74 offen offset:2048 sc1
    v_mfma_f32_16x16x32_bf16 v[44:47], v[136:139], v[96:99], v[44:47]
    v_mfma_f32_16x16x32_bf16 v[60:63], v[132:135], v[96:99], v[60:63]
    v_mfma_f32_16x16x32_bf16 v[76:79], v[128:131], v[96:99], v[76:79]
    s_waitcnt vmcnt(6)
    v_mfma_f32_16x16x32_bf16 v[12:15], v[124:127], v[160:163], v[12:15]
    buffer_load_dwordx4 v[240:243], v2, s[40:43], s74 offen offset:3072 sc1
    v_mfma_f32_16x16x32_bf16 v[32:35], v[120:123], v[160:163], v[32:35]
    v_mfma_f32_16x16x32_bf16 v[48:51], v[116:119], v[160:163], v[48:51]
    v_mfma_f32_16x16x32_bf16 v[64:67], v[112:115], v[160:163], v[64:67]
    s_waitcnt vmcnt(6)
    v_mfma_f32_16x16x32_bf16 v[16:19], v[124:127], v[192:195], v[16:19]
    s_bfe_u32 s74, s19, 0x40008
    s_mul_i32 s74, s74, 4096
    v_mfma_f32_16x16x32_bf16 v[36:39], v[120:123], v[192:195], v[36:39]
    s_add_u32 s74, s74, s69
    buffer_load_dwordx4 v[96:99], v2, s[40:43], s74 offen offset:0 sc1
    v_mfma_f32_16x16x32_bf16 v[52:55], v[116:119], v[192:195], v[52:55]
    v_mfma_f32_16x16x32_bf16 v[68:71], v[112:115], v[192:195], v[68:71]
    s_waitcnt vmcnt(6)
    v_mfma_f32_16x16x32_bf16 v[24:27], v[124:127], v[224:227], v[24:27]
    buffer_load_dwordx4 v[140:143], v2, s[40:43], s74 offen offset:1024 sc1
    v_mfma_f32_16x16x32_bf16 v[40:43], v[120:123], v[224:227], v[40:43]
    v_mfma_f32_16x16x32_bf16 v[56:59], v[116:119], v[224:227], v[56:59]
    v_mfma_f32_16x16x32_bf16 v[72:75], v[112:115], v[224:227], v[72:75]
    s_waitcnt vmcnt(6)
    v_mfma_f32_16x16x32_bf16 v[28:31], v[124:127], v[20:23], v[28:31]
    buffer_load_dwordx4 v[136:139], v2, s[40:43], s74 offen offset:2048 sc1
    v_mfma_f32_16x16x32_bf16 v[44:47], v[120:123], v[20:23], v[44:47]
    v_mfma_f32_16x16x32_bf16 v[60:63], v[116:119], v[20:23], v[60:63]
    v_mfma_f32_16x16x32_bf16 v[76:79], v[112:115], v[20:23], v[76:79]
    s_waitcnt lgkmcnt(15)
    s_waitcnt vmcnt(6)
    v_mfma_f32_16x16x32_bf16 v[12:15], v[92:95], v[144:147], v[12:15]
    buffer_load_dwordx4 v[132:135], v2, s[40:43], s74 offen offset:3072 sc1
    v_lshrrev_b32_e64 v192, 4, v0
    v_mfma_f32_16x16x32_bf16 v[32:35], v[252:255], v[144:147], v[32:35]
    v_lshlrev_b32 v192, 3, v192
    s_lshl_b32 s70, s61, 7
    v_mfma_f32_16x16x32_bf16 v[48:51], v[248:251], v[144:147], v[48:51]
    v_add_u32 v192, s70, v192
    v_add_u32 v193, s78, v2
    v_mfma_f32_16x16x32_bf16 v[64:67], v[244:247], v[144:147], v[64:67]
    global_load_dwordx2 v[128:129], v192, s[22:23] offset:0
    global_load_dwordx2 v[130:131], v192, s[22:23] offset:32
    s_waitcnt vmcnt(8)
    v_mfma_f32_16x16x32_bf16 v[16:19], v[92:95], v[176:179], v[16:19]
    s_bfe_u32 s74, s19, 0x4000c
    s_mul_i32 s74, s74, 4096
    v_mfma_f32_16x16x32_bf16 v[36:39], v[252:255], v[176:179], v[36:39]
    s_add_u32 s74, s74, s69
    buffer_load_dwordx4 v[224:227], v2, s[40:43], s74 offen offset:0 sc1
    v_mfma_f32_16x16x32_bf16 v[52:55], v[248:251], v[176:179], v[52:55]
    global_load_dwordx2 v[160:161], v192, s[22:23] offset:64
    global_load_dwordx2 v[162:163], v192, s[22:23] offset:96
    v_mfma_f32_16x16x32_bf16 v[68:71], v[244:247], v[176:179], v[68:71]
    s_waitcnt vmcnt(10)
    v_mfma_f32_16x16x32_bf16 v[24:27], v[92:95], v[208:211], v[24:27]
    buffer_load_dwordx4 v[20:23], v2, s[40:43], s74 offen offset:1024 sc1
    v_mfma_f32_16x16x32_bf16 v[40:43], v[252:255], v[208:211], v[40:43]
    v_mfma_f32_16x16x32_bf16 v[56:59], v[248:251], v[208:211], v[56:59]
    v_mfma_f32_16x16x32_bf16 v[72:75], v[244:247], v[208:211], v[72:75]
    s_waitcnt vmcnt(10)
    v_mfma_f32_16x16x32_bf16 v[28:31], v[92:95], v[240:243], v[28:31]
    buffer_load_dwordx4 v[124:127], v2, s[40:43], s74 offen offset:2048 sc1
    v_mfma_f32_16x16x32_bf16 v[44:47], v[252:255], v[240:243], v[44:47]
    v_mfma_f32_16x16x32_bf16 v[60:63], v[248:251], v[240:243], v[60:63]
    v_mfma_f32_16x16x32_bf16 v[76:79], v[244:247], v[240:243], v[76:79]
    s_waitcnt vmcnt(10)
    v_mfma_f32_16x16x32_bf16 v[12:15], v[108:111], v[96:99], v[12:15]
    buffer_load_dwordx4 v[120:123], v2, s[40:43], s74 offen offset:3072 sc1
    v_mfma_f32_16x16x32_bf16 v[32:35], v[236:239], v[96:99], v[32:35]
    v_mfma_f32_16x16x32_bf16 v[48:51], v[232:235], v[96:99], v[48:51]
    v_mfma_f32_16x16x32_bf16 v[64:67], v[228:231], v[96:99], v[64:67]
    s_waitcnt vmcnt(10)
    v_mfma_f32_16x16x32_bf16 v[16:19], v[108:111], v[140:143], v[16:19]
    s_bfe_u32 s74, s19, 0x40010
    s_mul_i32 s74, s74, 4096
    v_mfma_f32_16x16x32_bf16 v[36:39], v[236:239], v[140:143], v[36:39]
    s_add_u32 s74, s74, s69
    buffer_load_dwordx4 v[116:119], v2, s[40:43], s74 offen offset:0 sc1
    v_mfma_f32_16x16x32_bf16 v[52:55], v[232:235], v[140:143], v[52:55]
    v_mfma_f32_16x16x32_bf16 v[68:71], v[228:231], v[140:143], v[68:71]
    s_waitcnt vmcnt(10)
    v_mfma_f32_16x16x32_bf16 v[24:27], v[108:111], v[136:139], v[24:27]
    buffer_load_dwordx4 v[112:115], v2, s[40:43], s74 offen offset:1024 sc1
    v_mfma_f32_16x16x32_bf16 v[40:43], v[236:239], v[136:139], v[40:43]
    v_mfma_f32_16x16x32_bf16 v[56:59], v[232:235], v[136:139], v[56:59]
    v_mfma_f32_16x16x32_bf16 v[72:75], v[228:231], v[136:139], v[72:75]
    s_waitcnt vmcnt(10)
    v_mfma_f32_16x16x32_bf16 v[28:31], v[108:111], v[132:135], v[28:31]
    buffer_load_dwordx4 v[144:147], v2, s[40:43], s74 offen offset:2048 sc1
    v_mfma_f32_16x16x32_bf16 v[44:47], v[236:239], v[132:135], v[44:47]
    v_mfma_f32_16x16x32_bf16 v[60:63], v[232:235], v[132:135], v[60:63]
    v_mfma_f32_16x16x32_bf16 v[76:79], v[228:231], v[132:135], v[76:79]
    s_waitcnt vmcnt(8)
    v_mfma_f32_16x16x32_bf16 v[12:15], v[88:91], v[224:227], v[12:15]
    buffer_load_dwordx4 v[176:179], v2, s[40:43], s74 offen offset:3072 sc1
    v_mfma_f32_16x16x32_bf16 v[32:35], v[220:223], v[224:227], v[32:35]
    v_mfma_f32_16x16x32_bf16 v[48:51], v[216:219], v[224:227], v[48:51]
    v_mfma_f32_16x16x32_bf16 v[64:67], v[212:215], v[224:227], v[64:67]
    s_waitcnt vmcnt(6)
    v_mfma_f32_16x16x32_bf16 v[16:19], v[88:91], v[20:23], v[16:19]
    s_bfe_u32 s74, s19, 0x40014
    s_mul_i32 s74, s74, 4096
    v_mfma_f32_16x16x32_bf16 v[36:39], v[220:223], v[20:23], v[36:39]
    s_add_u32 s74, s74, s69
    buffer_load_dwordx4 v[208:211], v2, s[40:43], s74 offen offset:1024 sc1
    v_mfma_f32_16x16x32_bf16 v[52:55], v[216:219], v[20:23], v[52:55]
    v_mfma_f32_16x16x32_bf16 v[68:71], v[212:215], v[20:23], v[68:71]
    s_waitcnt vmcnt(6)
    v_mfma_f32_16x16x32_bf16 v[24:27], v[88:91], v[124:127], v[24:27]
    s_bfe_u32 s7, s19, 0x40018
    s_mul_i32 s7, s7, 4096
    v_mfma_f32_16x16x32_bf16 v[40:43], v[220:223], v[124:127], v[40:43]
    s_add_u32 s7, s7, s69
    buffer_load_dwordx4 v[240:243], v2, s[40:43], s7 offen offset:1024 sc1
    v_mfma_f32_16x16x32_bf16 v[56:59], v[216:219], v[124:127], v[56:59]
    v_lshlrev_b32 v92, 16, v128
    v_and_b32 v93, s67, v128
    v_mfma_f32_16x16x32_bf16 v[72:75], v[212:215], v[124:127], v[72:75]
    v_lshlrev_b32 v94, 16, v129
    v_and_b32_e64 v95, s67, v129
    s_waitcnt vmcnt(6)
    v_mfma_f32_16x16x32_bf16 v[28:31], v[88:91], v[120:123], v[28:31]
    s_bfe_u32 s8, s19, 0x4001c
    s_mul_i32 s8, s8, 4096
    v_mfma_f32_16x16x32_bf16 v[44:47], v[220:223], v[120:123], v[44:47]
    s_add_u32 s8, s8, s69
    buffer_load_dwordx4 v[136:139], v2, s[40:43], s8 offen offset:1024 sc1
    v_mfma_f32_16x16x32_bf16 v[60:63], v[216:219], v[120:123], v[60:63]
    v_lshlrev_b32 v252, 16, v130
    v_and_b32_e64 v253, s67, v130
    v_mfma_f32_16x16x32_bf16 v[76:79], v[212:215], v[120:123], v[76:79]
    v_lshlrev_b32 v254, 16, v131
    v_and_b32_e64 v255, s67, v131
    s_waitcnt vmcnt(6)
    v_mfma_f32_16x16x32_bf16 v[12:15], v[104:107], v[116:119], v[12:15]
    buffer_load_dwordx4 v[132:135], v2, s[40:43], s74 offen offset:2048 sc1
    v_lshlrev_b32_e64 v248, 16, v160
    v_mfma_f32_16x16x32_bf16 v[32:35], v[204:207], v[116:119], v[32:35]
    v_and_b32 v249, s67, v160
    v_lshlrev_b32 v250, 16, v161
    v_mfma_f32_16x16x32_bf16 v[48:51], v[200:203], v[116:119], v[48:51]
    v_and_b32 v251, s67, v161
    v_lshlrev_b32 v244, 16, v162
    v_mfma_f32_16x16x32_bf16 v[64:67], v[196:199], v[116:119], v[64:67]
    v_and_b32 v245, s67, v162
    v_lshlrev_b32_e64 v246, 16, v163
    s_waitcnt vmcnt(6)
    v_mfma_f32_16x16x32_bf16 v[16:19], v[104:107], v[112:115], v[16:19]
    buffer_load_dwordx4 v[108:111], v2, s[40:43], s7 offen offset:2048 sc1
    v_and_b32_e64 v247, s67, v163
    v_mfma_f32_16x16x32_bf16 v[36:39], v[204:207], v[112:115], v[36:39]
    s_lshl_b32 s10, s60, 2
    s_add_u32 s10, s10, s59
    v_mfma_f32_16x16x32_bf16 v[52:55], v[200:203], v[112:115], v[52:55]
    s_mul_i32 s11, s10, 52
    s_lshr_b32 s11, s11, 8
    v_mfma_f32_16x16x32_bf16 v[68:71], v[196:199], v[112:115], v[68:71]
    s_mul_i32 s73, s11, 5
    s_sub_u32 s73, s10, s73
    s_waitcnt vmcnt(6)
    v_mfma_f32_16x16x32_bf16 v[24:27], v[104:107], v[144:147], v[24:27]
    buffer_load_dwordx4 v[236:239], v2, s[40:43], s8 offen offset:2048 sc1
    s_mul_i32 s11, s11, 245760
    v_mfma_f32_16x16x32_bf16 v[40:43], v[204:207], v[144:147], v[40:43]
    s_lshl_b32 s73, s73, 10
    s_add_u32 s11, s11, s73
    v_mfma_f32_16x16x32_bf16 v[56:59], v[200:203], v[144:147], v[56:59]
    s_mul_i32 s73, s61, 10240
    s_add_u32 s11, s11, s73
    v_mfma_f32_16x16x32_bf16 v[72:75], v[196:199], v[144:147], v[72:75]
    s_add_u32 s11, s11, 0x700000
    s_add_u32 s17, s11, 5120
    s_waitcnt vmcnt(6)
    v_mfma_f32_16x16x32_bf16 v[28:31], v[104:107], v[176:179], v[28:31]
    buffer_load_dwordx4 v[232:235], v2, s[40:43], s74 offen offset:3072 sc1
    s_mul_i32 s10, s10, 24
    v_mfma_f32_16x16x32_bf16 v[44:47], v[204:207], v[176:179], v[44:47]
    s_add_u32 s10, s10, s61
    s_mul_i32 s10, s10, 16
    v_mfma_f32_16x16x32_bf16 v[60:63], v[200:203], v[176:179], v[60:63]
    s_add_u32 s10, s10, 0x30000
    s_mov_b32 s12, 0xbdd2d3e8
    v_mfma_f32_16x16x32_bf16 v[76:79], v[196:199], v[176:179], v[76:79]
    s_mov_b32 s14, 1.0
    v_mov_b32 v96, 0xc0135761
    s_waitcnt vmcnt(6)
    v_mfma_f32_16x16x32_bf16 v[16:19], v[84:87], v[208:211], v[16:19]
    buffer_load_dwordx4 v[228:231], v2, s[40:43], s7 offen offset:3072 sc1
    v_lshrrev_b32_e64 v140, 3, v0
    v_mfma_f32_16x16x32_bf16 v[36:39], v[188:191], v[208:211], v[36:39]
    v_and_b32 v141, 7, v0
    v_lshlrev_b32 v142, 12, v140
    v_mfma_f32_16x16x32_bf16 v[52:55], v[184:187], v[208:211], v[52:55]
    v_and_b32 v140, 6, v140
    v_xor_b32 v140, v140, v141
    v_mfma_f32_16x16x32_bf16 v[68:71], v[180:183], v[208:211], v[68:71]
    v_lshl_add_u32 v4, v140, 4, v142
    v_add_u32 v5, 31744, v4
    s_waitcnt lgkmcnt(8)
    s_waitcnt vmcnt(6)
    v_mfma_f32_16x16x32_bf16 v[16:19], v[100:103], v[240:243], v[16:19]
    buffer_load_dwordx4 v[224:227], v2, s[40:43], s8 offen offset:3072 sc1
    v_add_u32 v6, 63488, v4
    v_mfma_f32_16x16x32_bf16 v[36:39], v[172:175], v[240:243], v[36:39]
    v_add_u32 v7, 95232, v4
    s_mul_i32 s3, s59, 1572864
    v_mfma_f32_16x16x32_bf16 v[52:55], v[168:171], v[240:243], v[52:55]
    s_lshl_b32 s70, s66, 7
    s_add_u32 s3, s3, s70
    v_mfma_f32_16x16x32_bf16 v[68:71], v[164:167], v[240:243], v[68:71]
    s_sub_u32 s70, s59, 1
    s_and_b32 s70, s70, 3
    s_waitcnt lgkmcnt(0)
    s_waitcnt vmcnt(6)
    v_mfma_f32_16x16x32_bf16 v[16:19], v[80:83], v[136:139], v[16:19]
    buffer_load_dwordx4 v[20:23], v2, s[40:43], s74 offen offset:0 sc1
    s_mul_i32 s70, s70, 28672
    v_mfma_f32_16x16x32_bf16 v[36:39], v[156:159], v[136:139], v[36:39]
    s_add_u32 s70, s70, 46336
    v_add_u32_e64 v140, s70, v2
    v_mfma_f32_16x16x32_bf16 v[52:55], v[152:155], v[136:139], v[52:55]
    s_sub_u32 s70, s59, 2
    s_and_b32 s70, s70, 3
    v_mfma_f32_16x16x32_bf16 v[68:71], v[148:151], v[136:139], v[68:71]
    s_mul_i32 s70, s70, 28672
    s_add_u32 s70, s70, 46336
    s_waitcnt vmcnt(6)
    v_mfma_f32_16x16x32_bf16 v[24:27], v[84:87], v[132:135], v[24:27]
    buffer_load_dwordx4 v[124:127], v2, s[40:43], s7 offen offset:0 sc1
    v_add_u32 v141, s70, v2
    v_mfma_f32_16x16x32_bf16 v[40:43], v[188:191], v[132:135], v[40:43]
    s_sub_u32 s70, s59, 3
    s_and_b32 s70, s70, 3
    v_mfma_f32_16x16x32_bf16 v[56:59], v[184:187], v[132:135], v[56:59]
    s_mul_i32 s70, s70, 28672
    s_add_u32 s70, s70, 46336
    v_mfma_f32_16x16x32_bf16 v[72:75], v[180:183], v[132:135], v[72:75]
    v_add_u32_e64 v142, s70, v2
    ds_write_b128 v193, v[16:19] offset:4096
    s_waitcnt vmcnt(6)
    v_mfma_f32_16x16x32_bf16 v[24:27], v[100:103], v[108:111], v[24:27]
    buffer_load_dwordx4 v[120:123], v2, s[40:43], s8 offen offset:0 sc1
    ds_write_b128 v193, v[36:39] offset:5120
    v_mfma_f32_16x16x32_bf16 v[40:43], v[172:175], v[108:111], v[40:43]
    ds_write_b128 v193, v[52:55] offset:6144
    ds_write_b128 v193, v[68:71] offset:7168
    v_mfma_f32_16x16x32_bf16 v[56:59], v[168:171], v[108:111], v[56:59]
    v_mfma_f32_16x16x32_bf16 v[72:75], v[164:167], v[108:111], v[72:75]
    s_waitcnt vmcnt(6)
    v_mfma_f32_16x16x32_bf16 v[24:27], v[80:83], v[236:239], v[24:27]
    v_mfma_f32_16x16x32_bf16 v[40:43], v[156:159], v[236:239], v[40:43]
    v_mfma_f32_16x16x32_bf16 v[56:59], v[152:155], v[236:239], v[56:59]
    v_mfma_f32_16x16x32_bf16 v[72:75], v[148:151], v[236:239], v[72:75]
    s_waitcnt vmcnt(5)
    v_mfma_f32_16x16x32_bf16 v[28:31], v[84:87], v[232:235], v[28:31]
    v_mfma_f32_16x16x32_bf16 v[44:47], v[188:191], v[232:235], v[44:47]
    v_mfma_f32_16x16x32_bf16 v[60:63], v[184:187], v[232:235], v[60:63]
    v_mfma_f32_16x16x32_bf16 v[76:79], v[180:183], v[232:235], v[76:79]
    ds_write_b128 v193, v[24:27] offset:8192
    ds_write_b128 v193, v[40:43] offset:9216
    s_waitcnt vmcnt(4)
    v_mfma_f32_16x16x32_bf16 v[28:31], v[100:103], v[228:231], v[28:31]
    ds_write_b128 v193, v[56:59] offset:10240
    ds_write_b128 v193, v[72:75] offset:11264
    v_mfma_f32_16x16x32_bf16 v[44:47], v[172:175], v[228:231], v[44:47]
    v_mfma_f32_16x16x32_bf16 v[60:63], v[168:171], v[228:231], v[60:63]
    v_mfma_f32_16x16x32_bf16 v[76:79], v[164:167], v[228:231], v[76:79]
    s_waitcnt vmcnt(3)
    v_mfma_f32_16x16x32_bf16 v[28:31], v[80:83], v[224:227], v[28:31]
    v_mfma_f32_16x16x32_bf16 v[44:47], v[156:159], v[224:227], v[44:47]
    v_mfma_f32_16x16x32_bf16 v[60:63], v[152:155], v[224:227], v[60:63]
    v_mfma_f32_16x16x32_bf16 v[76:79], v[148:151], v[224:227], v[76:79]
    s_waitcnt vmcnt(2)
    v_mfma_f32_16x16x32_bf16 v[12:15], v[84:87], v[20:23], v[12:15]
    v_mfma_f32_16x16x32_bf16 v[32:35], v[188:191], v[20:23], v[32:35]
    v_mfma_f32_16x16x32_bf16 v[48:51], v[184:187], v[20:23], v[48:51]
    v_mfma_f32_16x16x32_bf16 v[64:67], v[180:183], v[20:23], v[64:67]
    ds_write_b128 v193, v[28:31] offset:12288
    ds_write_b128 v193, v[44:47] offset:13312
    s_waitcnt vmcnt(1)
    v_mfma_f32_16x16x32_bf16 v[12:15], v[100:103], v[124:127], v[12:15]
    ds_write_b128 v193, v[60:63] offset:14336
    ds_write_b128 v193, v[76:79] offset:15360
    v_mfma_f32_16x16x32_bf16 v[32:35], v[172:175], v[124:127], v[32:35]
    v_mfma_f32_16x16x32_bf16 v[48:51], v[168:171], v[124:127], v[48:51]
    v_mfma_f32_16x16x32_bf16 v[64:67], v[164:167], v[124:127], v[64:67]
    s_waitcnt vmcnt(0)
    v_mfma_f32_16x16x32_bf16 v[12:15], v[80:83], v[120:123], v[12:15]
    v_mfma_f32_16x16x32_bf16 v[32:35], v[156:159], v[120:123], v[32:35]
    v_mfma_f32_16x16x32_bf16 v[48:51], v[152:155], v[120:123], v[48:51]
    v_mfma_f32_16x16x32_bf16 v[64:67], v[148:151], v[120:123], v[64:67]
    s_waitcnt lgkmcnt(0)
    s_mov_b64 exec, 1
    ds_add_u32 v1, v3 offset:4
    s_mov_b64 exec, -1
    s_bfe_u32 s79, s34, 0x40000
    s_mul_i32 s79, s79, 131072
    s_add_u32 s79, s79, s3
    s_add_u32 m0, s78, 16384
    s_nop 0
    buffer_load_dwordx4 v4, s[48:51], s79 offen offset:0 lds
    buffer_load_dwordx4 v5, s[48:51], s79 offen offset:1024 lds
    buffer_load_dwordx4 v6, s[48:51], s79 offen offset:2048 lds
    buffer_load_dwordx4 v7, s[48:51], s79 offen offset:3072 lds
    s_bfe_u32 s79, s34, 0x40004
    s_mul_i32 s79, s79, 131072
    s_add_u32 s79, s79, s3
    s_add_u32 m0, s78, 20480
    s_nop 0
    buffer_load_dwordx4 v4, s[48:51], s79 offen offset:0 lds
    buffer_load_dwordx4 v5, s[48:51], s79 offen offset:1024 lds
    buffer_load_dwordx4 v6, s[48:51], s79 offen offset:2048 lds
    buffer_load_dwordx4 v7, s[48:51], s79 offen offset:3072 lds
    s_bfe_u32 s79, s34, 0x40008
    s_mul_i32 s79, s79, 131072
    s_add_u32 s79, s79, s3
    s_add_u32 m0, s78, 24576
    s_nop 0
    buffer_load_dwordx4 v4, s[48:51], s79 offen offset:0 lds
    buffer_load_dwordx4 v5, s[48:51], s79 offen offset:1024 lds
    buffer_load_dwordx4 v6, s[48:51], s79 offen offset:2048 lds
    buffer_load_dwordx4 v7, s[48:51], s79 offen offset:3072 lds
    s_mov_b32 s68, 0
L_lw_6:
    ds_read_b32 v143, v1 offset:4
    s_waitcnt lgkmcnt(0)
    v_readfirstlane_b32 s70, v143
    s_nop 0
    s_cmp_ge_u32 s70, 4
    s_cbranch_scc1 L_lwd_7
    s_add_u32 s68, s68, 1
    s_cmp_lt_u32 s68, 0x200000
    s_cbranch_scc1 L_lw_6
L_lwd_7:
    ds_read_b128 v[220:223], v140 offset:4096
    ds_read_b128 v[216:219], v141 offset:8192
    ds_read_b128 v[212:215], v142 offset:12288
    ds_read_b128 v[116:119], v140 offset:5120
    ds_read_b128 v[112:115], v141 offset:9216
    ds_read_b128 v[144:147], v142 offset:13312
    ds_read_b128 v[176:179], v140 offset:6144
    ds_read_b128 v[104:107], v141 offset:10240
    ds_read_b128 v[204:207], v142 offset:14336
    ds_read_b128 v[200:203], v140 offset:7168
    ds_read_b128 v[196:199], v141 offset:11264
    ds_read_b128 v[208:211], v142 offset:15360
    s_waitcnt lgkmcnt(9)
    v_pk_add_f32 v[12:13], v[12:13], v[220:221]
    v_pk_add_f32 v[216:217], v[216:217], v[212:213]
    v_pk_add_f32 v[14:15], v[14:15], v[222:223]
    v_pk_add_f32 v[218:219], v[218:219], v[214:215]
    v_pk_add_f32 v[12:13], v[12:13], v[216:217]
    v_pk_add_f32 v[14:15], v[14:15], v[218:219]
    v_cvt_pk_bf16_f32 v108, v12, v13
    v_cvt_pk_bf16_f32 v110, v14, v15
    v_lshlrev_b32 v12, 16, v108
    v_and_b32 v13, s67, v108
    v_lshlrev_b32 v14, 16, v110
    v_and_b32 v15, s67, v110
    v_pk_add_f32 v[12:13], v[12:13], v[92:93]
    v_pk_add_f32 v[14:15], v[14:15], v[94:95]
    v_cvt_pk_bf16_f32 v108, v12, v13
    v_cvt_pk_bf16_f32 v110, v14, v15
    v_lshlrev_b32 v12, 16, v108
    v_and_b32 v13, s67, v108
    v_lshlrev_b32 v14, 16, v110
    v_and_b32 v15, s67, v110
    v_pk_mul_f32 v[132:133], v[12:13], v[12:13]
    v_pk_mul_f32 v[134:135], v[14:15], v[14:15]
    v_pk_fma_f32 v[132:133], v[132:133], s[12:13], v[96:97] op_sel_hi:[1,0,0]
    v_pk_fma_f32 v[134:135], v[134:135], s[12:13], v[96:97] op_sel_hi:[1,0,0]
    v_pk_mul_f32 v[132:133], v[132:133], v[12:13]
    v_pk_mul_f32 v[134:135], v[134:135], v[14:15]
    v_exp_f32 v132, v132
    v_exp_f32 v133, v133
    v_exp_f32 v134, v134
    v_exp_f32 v135, v135
    v_pk_add_f32 v[132:133], v[132:133], s[14:15] op_sel_hi:[1,0]
    v_pk_add_f32 v[134:135], v[134:135], s[14:15] op_sel_hi:[1,0]
    v_rcp_f32 v132, v132
    v_rcp_f32 v133, v133
    v_rcp_f32 v134, v134
    v_rcp_f32 v135, v135
    v_pk_mul_f32 v[12:13], v[12:13], v[132:133]
    v_pk_mul_f32 v[14:15], v[14:15], v[134:135]
    v_cvt_pk_bf16_f32 v240, v12, v13
    v_cvt_pk_bf16_f32 v241, v14, v15
    s_waitcnt lgkmcnt(6)
    s_nop 0
    v_pk_add_f32 v[32:33], v[32:33], v[116:117]
    v_pk_add_f32 v[112:113], v[112:113], v[144:145]
    v_pk_add_f32 v[34:35], v[34:35], v[118:119]
    v_pk_add_f32 v[114:115], v[114:115], v[146:147]
    v_pk_add_f32 v[32:33], v[32:33], v[112:113]
    v_pk_add_f32 v[34:35], v[34:35], v[114:115]
    v_cvt_pk_bf16_f32 v108, v32, v33
    v_cvt_pk_bf16_f32 v110, v34, v35
    v_lshlrev_b32 v32, 16, v108
    v_and_b32 v33, s67, v108
    v_lshlrev_b32 v34, 16, v110
    v_and_b32 v35, s67, v110
    v_pk_add_f32 v[32:33], v[32:33], v[252:253]
    v_pk_add_f32 v[34:35], v[34:35], v[254:255]
    v_cvt_pk_bf16_f32 v108, v32, v33
    v_cvt_pk_bf16_f32 v110, v34, v35
    v_lshlrev_b32 v32, 16, v108
    v_and_b32 v33, s67, v108
    v_lshlrev_b32 v34, 16, v110
    v_and_b32 v35, s67, v110
    v_pk_mul_f32 v[132:133], v[32:33], v[32:33]
    v_pk_mul_f32 v[134:135], v[34:35], v[34:35]
    v_pk_fma_f32 v[132:133], v[132:133], s[12:13], v[96:97] op_sel_hi:[1,0,0]
    v_pk_fma_f32 v[134:135], v[134:135], s[12:13], v[96:97] op_sel_hi:[1,0,0]
    v_pk_mul_f32 v[132:133], v[132:133], v[32:33]
    v_pk_mul_f32 v[134:135], v[134:135], v[34:35]
    v_exp_f32 v132, v132
    v_exp_f32 v133, v133
    v_exp_f32 v134, v134
    v_exp_f32 v135, v135
    v_pk_add_f32 v[132:133], v[132:133], s[14:15] op_sel_hi:[1,0]
    v_pk_add_f32 v[134:135], v[134:135], s[14:15] op_sel_hi:[1,0]
    v_rcp_f32 v132, v132
    v_rcp_f32 v133, v133
    v_rcp_f32 v134, v134
    v_rcp_f32 v135, v135
    v_pk_mul_f32 v[32:33], v[32:33], v[132:133]
    v_pk_mul_f32 v[34:35], v[34:35], v[134:135]
    v_cvt_pk_bf16_f32 v242, v32, v33
    v_cvt_pk_bf16_f32 v243, v34, v35
    buffer_store_dwordx4 v[240:243], v2, s[40:43], s11 offen sc1
    s_waitcnt lgkmcnt(3)
    s_nop 0
    v_pk_add_f32 v[48:49], v[48:49], v[176:177]
    v_pk_add_f32 v[104:105], v[104:105], v[204:205]
    v_pk_add_f32 v[50:51], v[50:51], v[178:179]
    v_pk_add_f32 v[106:107], v[106:107], v[206:207]
    v_pk_add_f32 v[48:49], v[48:49], v[104:105]
    v_pk_add_f32 v[50:51], v[50:51], v[106:107]
    v_cvt_pk_bf16_f32 v108, v48, v49
    v_cvt_pk_bf16_f32 v110, v50, v51
    v_lshlrev_b32 v48, 16, v108
    v_and_b32 v49, s67, v108
    v_lshlrev_b32 v50, 16, v110
    v_and_b32 v51, s67, v110
    v_pk_add_f32 v[48:49], v[48:49], v[248:249]
    v_pk_add_f32 v[50:51], v[50:51], v[250:251]
    v_cvt_pk_bf16_f32 v108, v48, v49
    v_cvt_pk_bf16_f32 v110, v50, v51
    v_lshlrev_b32 v48, 16, v108
    v_and_b32 v49, s67, v108
    v_lshlrev_b32 v50, 16, v110
    v_and_b32 v51, s67, v110
    v_pk_mul_f32 v[132:133], v[48:49], v[48:49]
    v_pk_mul_f32 v[134:135], v[50:51], v[50:51]
    v_pk_fma_f32 v[132:133], v[132:133], s[12:13], v[96:97] op_sel_hi:[1,0,0]
    v_pk_fma_f32 v[134:135], v[134:135], s[12:13], v[96:97] op_sel_hi:[1,0,0]
    v_pk_mul_f32 v[132:133], v[132:133], v[48:49]
    v_pk_mul_f32 v[134:135], v[134:135], v[50:51]
    v_exp_f32 v132, v132
    v_exp_f32 v133, v133
    v_exp_f32 v134, v134
    v_exp_f32 v135, v135
    v_pk_add_f32 v[132:133], v[132:133], s[14:15] op_sel_hi:[1,0]
    v_pk_add_f32 v[134:135], v[134:135], s[14:15] op_sel_hi:[1,0]
    v_rcp_f32 v132, v132
    v_rcp_f32 v133, v133
    v_rcp_f32 v134, v134
    v_rcp_f32 v135, v135
    v_pk_mul_f32 v[48:49], v[48:49], v[132:133]
    v_pk_mul_f32 v[50:51], v[50:51], v[134:135]
    v_cvt_pk_bf16_f32 v136, v48, v49
    v_cvt_pk_bf16_f32 v137, v50, v51
    s_waitcnt lgkmcnt(0)
    s_nop 0
    v_pk_add_f32 v[64:65], v[64:65], v[200:201]
    v_pk_add_f32 v[196:197], v[196:197], v[208:209]
    v_pk_add_f32 v[66:67], v[66:67], v[202:203]
    v_pk_add_f32 v[198:199], v[198:199], v[210:211]
    v_pk_add_f32 v[64:65], v[64:65], v[196:197]
    v_pk_add_f32 v[66:67], v[66:67], v[198:199]
    v_cvt_pk_bf16_f32 v108, v64, v65
    v_cvt_pk_bf16_f32 v110, v66, v67
    v_lshlrev_b32 v64, 16, v108
    v_and_b32 v65, s67, v108
    v_lshlrev_b32 v66, 16, v110
    v_and_b32 v67, s67, v110
    v_pk_add_f32 v[64:65], v[64:65], v[244:245]
    v_pk_add_f32 v[66:67], v[66:67], v[246:247]
    v_cvt_pk_bf16_f32 v108, v64, v65
    v_cvt_pk_bf16_f32 v110, v66, v67
    v_lshlrev_b32 v64, 16, v108
    v_and_b32 v65, s67, v108
    v_lshlrev_b32 v66, 16, v110
    v_and_b32 v67, s67, v110
    v_pk_mul_f32 v[132:133], v[64:65], v[64:65]
    v_pk_mul_f32 v[134:135], v[66:67], v[66:67]
    v_pk_fma_f32 v[132:133], v[132:133], s[12:13], v[96:97] op_sel_hi:[1,0,0]
    v_pk_fma_f32 v[134:135], v[134:135], s[12:13], v[96:97] op_sel_hi:[1,0,0]
    v_pk_mul_f32 v[132:133], v[132:133], v[64:65]
    v_pk_mul_f32 v[134:135], v[134:135], v[66:67]
    v_exp_f32 v132, v132
    v_exp_f32 v133, v133
    v_exp_f32 v134, v134
    v_exp_f32 v135, v135
    v_pk_add_f32 v[132:133], v[132:133], s[14:15] op_sel_hi:[1,0]
    v_pk_add_f32 v[134:135], v[134:135], s[14:15] op_sel_hi:[1,0]
    v_rcp_f32 v132, v132
    v_rcp_f32 v133, v133
    v_rcp_f32 v134, v134
    v_rcp_f32 v135, v135
    v_pk_mul_f32 v[64:65], v[64:65], v[132:133]
    v_pk_mul_f32 v[66:67], v[66:67], v[134:135]
    v_cvt_pk_bf16_f32 v138, v64, v65
    v_cvt_pk_bf16_f32 v139, v66, v67
    buffer_store_dwordx4 v[136:139], v2, s[40:43], s17 offen sc1
    s_mov_b64 exec, 1
    ds_add_u32 v1, v3 offset:8
    s_mov_b64 exec, -1
    v_lshrrev_b32_e64 v12, 4, v0
    v_bfe_u32 v13, v0, 2, 2
    v_and_b32_e64 v14, 3, v0
    v_lshl_add_u32 v15, v12, 2, v13
    v_bfe_u32 v16, v15, 1, 2
    v_xor_b32 v16, s59, v16
    v_lshlrev_b32 v15, 7, v15
    v_lshl_add_u32 v15, v14, 3, v15
    v_add_u32 v15, s78, v15
    v_xor_b32 v17, 0, v16
    v_lshl_add_u32 v8, v17, 5, v15
    v_xor_b32_e64 v17, 1, v16
    v_lshl_add_u32 v9, v17, 5, v15
    v_xor_b32_e64 v17, 2, v16
    v_lshl_add_u32 v10, v17, 5, v15
    v_xor_b32_e64 v17, 3, v16
    v_lshl_add_u32 v11, v17, 5, v15
    v_mov_b32 v12, s56
    v_mov_b32 v13, s57
    s_waitcnt vmcnt(0)
    s_mov_b64 exec, 1
    buffer_store_dwordx2 v[12:13], v1, s[40:43], s10 offen sc1
    s_mov_b64 exec, -1
    s_bfe_u32 s79, s34, 0x4000c
    s_mul_i32 s79, s79, 131072
    s_add_u32 s79, s79, s3
    s_add_u32 m0, s78, 0
    s_nop 0
    buffer_load_dwordx4 v4, s[48:51], s79 offen offset:0 lds
    buffer_load_dwordx4 v5, s[48:51], s79 offen offset:1024 lds
    buffer_load_dwordx4 v6, s[48:51], s79 offen offset:2048 lds
    buffer_load_dwordx4 v7, s[48:51], s79 offen offset:3072 lds
    s_mov_b32 s68, 0
L_lw_8:
    ds_read_b32 v14, v1 offset:8
    s_waitcnt lgkmcnt(0)
    v_readfirstlane_b32 s70, v14
    s_nop 0
    s_cmp_ge_u32 s70, 4
    s_cbranch_scc1 L_lwd_9
    s_add_u32 s68, s68, 1
    s_cmp_lt_u32 s68, 0x200000
    s_cbranch_scc1 L_lw_8
L_lwd_9:
    s_bfe_u32 s79, s34, 0x40010
    s_mul_i32 s79, s79, 131072
    s_add_u32 s79, s79, s3
    s_add_u32 m0, s78, 4096
    s_nop 0
    buffer_load_dwordx4 v4, s[48:51], s79 offen offset:0 lds
    buffer_load_dwordx4 v5, s[48:51], s79 offen offset:1024 lds
    buffer_load_dwordx4 v6, s[48:51], s79 offen offset:2048 lds
    buffer_load_dwordx4 v7, s[48:51], s79 offen offset:3072 lds
    s_bfe_u32 s79, s34, 0x40014
    s_mul_i32 s79, s79, 131072
    s_add_u32 s79, s79, s3
    s_add_u32 m0, s78, 8192
    s_nop 0
    buffer_load_dwordx4 v4, s[48:51], s79 offen offset:0 lds
    buffer_load_dwordx4 v5, s[48:51], s79 offen offset:1024 lds
    buffer_load_dwordx4 v6, s[48:51], s79 offen offset:2048 lds
    buffer_load_dwordx4 v7, s[48:51], s79 offen offset:3072 lds
    s_bfe_u32 s79, s34, 0x40018
    s_mul_i32 s79, s79, 131072
    s_add_u32 s79, s79, s3
    s_add_u32 m0, s78, 12288
    s_nop 0
    buffer_load_dwordx4 v4, s[48:51], s79 offen offset:0 lds
    buffer_load_dwordx4 v5, s[48:51], s79 offen offset:1024 lds
    buffer_load_dwordx4 v6, s[48:51], s79 offen offset:2048 lds
    buffer_load_dwordx4 v7, s[48:51], s79 offen offset:3072 lds
    s_branch L_G_join
L_G_idle:
    v_lshrrev_b32 v12, 3, v0
    v_and_b32 v13, 7, v0
    v_lshlrev_b32 v12, 12, v12
    v_lshl_add_u32 v12, v13, 6, v12
    s_lshr_b32 s70, s2, 3
    s_and_b32 s70, s70, 1
    s_lshl_b32 s70, s70, 16
    s_mul_i32 s71, s59, 1572864
    s_add_u32 s72, s70, s71
    s_and_b32 s71, s2, 7
    s_lshl_b32 s71, s71, 9
    s_add_u32 s72, s72, s71
    s_lshl_b32 s70, s9, 17
    s_add_u32 s70, s70, s72
    s_add_u32 s71, s70, 32768
    buffer_load_dword v14, v12, s[48:51], s70 offen
    s_waitcnt vmcnt(1)
    buffer_load_dword v14, v12, s[48:51], s71 offen
    s_waitcnt vmcnt(1)
    s_add_u32 s9, s9, 1
    s_cmp_ge_u32 s9, 12
    s_cselect_b32 s9, 0, s9
    s_lshl_b32 s70, s9, 17
    s_add_u32 s70, s70, s72
    s_add_u32 s71, s70, 32768
    buffer_load_dword v14, v12, s[48:51], s70 offen
    s_waitcnt vmcnt(1)
    buffer_load_dword v14, v12, s[48:51], s71 offen
    s_waitcnt vmcnt(1)
    s_add_u32 s9, s9, 1
    s_cmp_ge_u32 s9, 12
    s_cselect_b32 s9, 0, s9
    s_lshl_b32 s70, s9, 17
    s_add_u32 s70, s70, s72
    s_add_u32 s71, s70, 32768
    buffer_load_dword v14, v12, s[48:51], s70 offen
    s_waitcnt vmcnt(1)
    buffer_load_dword v14, v12, s[48:51], s71 offen
    s_waitcnt vmcnt(1)
    s_add_u32 s9, s9, 1
    s_cmp_ge_u32 s9, 12
    s_cselect_b32 s9, 0, s9
    s_lshl_b32 s70, s9, 17
    s_add_u32 s70, s70, s72
    s_add_u32 s71, s70, 32768
    buffer_load_dword v14, v12, s[48:51], s70 offen
    s_waitcnt vmcnt(1)
    buffer_load_dword v14, v12, s[48:51], s71 offen
    s_waitcnt vmcnt(1)
    s_add_u32 s9, s9, 1
    s_cmp_ge_u32 s9, 12
    s_cselect_b32 s9, 0, s9
    s_lshl_b32 s70, s9, 17
    s_add_u32 s70, s70, s72
    s_add_u32 s71, s70, 32768
    buffer_load_dword v14, v12, s[48:51], s70 offen
    s_waitcnt vmcnt(1)
    buffer_load_dword v14, v12, s[48:51], s71 offen
    s_waitcnt vmcnt(1)
    s_add_u32 s9, s9, 1
    s_cmp_ge_u32 s9, 12
    s_cselect_b32 s9, 0, s9
    s_lshl_b32 s70, s9, 17
    s_add_u32 s70, s70, s72
    s_add_u32 s71, s70, 32768
    buffer_load_dword v14, v12, s[48:51], s70 offen
    s_waitcnt vmcnt(1)
    buffer_load_dword v14, v12, s[48:51], s71 offen
    s_waitcnt vmcnt(1)
    s_add_u32 s9, s9, 1
    s_cmp_ge_u32 s9, 12
    s_cselect_b32 s9, 0, s9
    s_lshl_b32 s70, s9, 17
    s_add_u32 s70, s70, s72
    s_add_u32 s71, s70, 32768
    buffer_load_dword v14, v12, s[48:51], s70 offen
    s_waitcnt vmcnt(1)
    buffer_load_dword v14, v12, s[48:51], s71 offen
    s_waitcnt vmcnt(1)
    s_add_u32 s9, s9, 1
    s_cmp_ge_u32 s9, 12
    s_cselect_b32 s9, 0, s9
    s_waitcnt vmcnt(0)
    v_lshrrev_b32 v12, 3, v0
    v_and_b32_e64 v13, 7, v0
    v_mul_u32_u24 v14, 4096, v12
    v_and_b32 v15, 6, v12
    v_xor_b32 v16, v13, v15
    v_lshl_add_u32 v4, v16, 4, v14
    v_add_u32 v5, 31744, v4
    v_add_u32 v6, 63488, v4
    v_add_u32 v7, 95232, v4
    s_mul_i32 s3, s59, 1572864
    s_lshl_b32 s70, s66, 7
    s_add_u32 s3, s3, s70
    s_bfe_u32 s79, s34, 0x40000
    s_mul_i32 s79, s79, 131072
    s_add_u32 s79, s79, s3
    s_add_u32 m0, s78, 16384
    s_nop 0
    buffer_load_dwordx4 v4, s[48:51], s79 offen offset:0 lds
    buffer_load_dwordx4 v5, s[48:51], s79 offen offset:1024 lds
    buffer_load_dwordx4 v6, s[48:51], s79 offen offset:2048 lds
    buffer_load_dwordx4 v7, s[48:51], s79 offen offset:3072 lds
    s_bfe_u32 s79, s34, 0x40004
    s_mul_i32 s79, s79, 131072
    s_add_u32 s79, s79, s3
    s_add_u32 m0, s78, 20480
    s_nop 0
    buffer_load_dwordx4 v4, s[48:51], s79 offen offset:0 lds
    buffer_load_dwordx4 v5, s[48:51], s79 offen offset:1024 lds
    buffer_load_dwordx4 v6, s[48:51], s79 offen offset:2048 lds
    buffer_load_dwordx4 v7, s[48:51], s79 offen offset:3072 lds
    s_bfe_u32 s79, s34, 0x40008
    s_mul_i32 s79, s79, 131072
    s_add_u32 s79, s79, s3
    s_add_u32 m0, s78, 24576
    s_nop 0
    buffer_load_dwordx4 v4, s[48:51], s79 offen offset:0 lds
    buffer_load_dwordx4 v5, s[48:51], s79 offen offset:1024 lds
    buffer_load_dwordx4 v6, s[48:51], s79 offen offset:2048 lds
    buffer_load_dwordx4 v7, s[48:51], s79 offen offset:3072 lds
    s_bfe_u32 s79, s34, 0x4000c
    s_mul_i32 s79, s79, 131072
    s_add_u32 s79, s79, s3
    s_add_u32 m0, s78, 0
    s_nop 0
    buffer_load_dwordx4 v4, s[48:51], s79 offen offset:0 lds
    buffer_load_dwordx4 v5, s[48:51], s79 offen offset:1024 lds
    buffer_load_dwordx4 v6, s[48:51], s79 offen offset:2048 lds
    buffer_load_dwordx4 v7, s[48:51], s79 offen offset:3072 lds
    s_bfe_u32 s79, s34, 0x40010
    s_mul_i32 s79, s79, 131072
    s_add_u32 s79, s79, s3
    s_add_u32 m0, s78, 4096
    s_nop 0
    buffer_load_dwordx4 v4, s[48:51], s79 offen offset:0 lds
    buffer_load_dwordx4 v5, s[48:51], s79 offen offset:1024 lds
    buffer_load_dwordx4 v6, s[48:51], s79 offen offset:2048 lds
    buffer_load_dwordx4 v7, s[48:51], s79 offen offset:3072 lds
    s_bfe_u32 s79, s34, 0x40014
    s_mul_i32 s79, s79, 131072
    s_add_u32 s79, s79, s3
    s_add_u32 m0, s78, 8192
    s_nop 0
    buffer_load_dwordx4 v4, s[48:51], s79 offen offset:0 lds
    buffer_load_dwordx4 v5, s[48:51], s79 offen offset:1024 lds
    buffer_load_dwordx4 v6, s[48:51], s79 offen offset:2048 lds
    buffer_load_dwordx4 v7, s[48:51], s79 offen offset:3072 lds
    s_bfe_u32 s79, s34, 0x40018
    s_mul_i32 s79, s79, 131072
    s_add_u32 s79, s79, s3
    s_add_u32 m0, s78, 12288
    s_nop 0
    buffer_load_dwordx4 v4, s[48:51], s79 offen offset:0 lds
    buffer_load_dwordx4 v5, s[48:51], s79 offen offset:1024 lds
    buffer_load_dwordx4 v6, s[48:51], s79 offen offset:2048 lds
    buffer_load_dwordx4 v7, s[48:51], s79 offen offset:3072 lds
    v_lshrrev_b32 v12, 4, v0
    v_bfe_u32 v13, v0, 2, 2
    v_and_b32_e64 v14, 3, v0
    v_lshl_add_u32 v15, v12, 2, v13
    v_bfe_u32 v16, v15, 1, 2
    v_xor_b32 v16, s59, v16
    v_lshlrev_b32 v15, 7, v15
    v_lshl_add_u32 v15, v14, 3, v15
    v_add_u32 v15, s78, v15
    v_xor_b32 v17, 0, v16
    v_lshl_add_u32 v8, v17, 5, v15
    v_xor_b32_e64 v17, 1, v16
    v_lshl_add_u32 v9, v17, 5, v15
    v_xor_b32_e64 v17, 2, v16
    v_lshl_add_u32 v10, v17, 5, v15
    v_xor_b32_e64 v17, 3, v16
    v_lshl_add_u32 v11, v17, 5, v15
    s_waitcnt vmcnt(0)
L_G_join:
    ds_read_b64_tr_b16 v[136:137], v8 offset:16384
    ds_read_b64_tr_b16 v[138:139], v8 offset:18432
    ds_read_b64_tr_b16 v[240:241], v9 offset:16384
    ds_read_b64_tr_b16 v[242:243], v9 offset:18432
    ds_read_b64_tr_b16 v[252:253], v10 offset:16384
    ds_read_b64_tr_b16 v[254:255], v10 offset:18432
    ds_read_b64_tr_b16 v[248:249], v11 offset:16384
    ds_read_b64_tr_b16 v[250:251], v11 offset:18432
    s_waitcnt lgkmcnt(0)
    s_bfe_u32 s79, s34, 0x4001c
    s_mul_i32 s79, s79, 131072
    s_add_u32 s79, s79, s3
    s_add_u32 m0, s78, 16384
    s_nop 0
    buffer_load_dwordx4 v4, s[48:51], s79 offen offset:0 lds
    buffer_load_dwordx4 v5, s[48:51], s79 offen offset:1024 lds
    buffer_load_dwordx4 v6, s[48:51], s79 offen offset:2048 lds
    buffer_load_dwordx4 v7, s[48:51], s79 offen offset:3072 lds
    ds_read_b64_tr_b16 v[244:245], v8 offset:20480
    ds_read_b64_tr_b16 v[246:247], v8 offset:22528
    ds_read_b64_tr_b16 v[236:237], v9 offset:20480
    ds_read_b64_tr_b16 v[238:239], v9 offset:22528
    ds_read_b64_tr_b16 v[232:233], v10 offset:20480
    ds_read_b64_tr_b16 v[234:235], v10 offset:22528
    ds_read_b64_tr_b16 v[228:229], v11 offset:20480
    ds_read_b64_tr_b16 v[230:231], v11 offset:22528
    s_waitcnt lgkmcnt(0)
    s_bfe_u32 s79, s35, 0x40000
    s_mul_i32 s79, s79, 131072
    s_add_u32 s79, s79, s3
    s_add_u32 m0, s78, 20480
    s_nop 0
    buffer_load_dwordx4 v4, s[48:51], s79 offen offset:0 lds
    buffer_load_dwordx4 v5, s[48:51], s79 offen offset:1024 lds
    buffer_load_dwordx4 v6, s[48:51], s79 offen offset:2048 lds
    buffer_load_dwordx4 v7, s[48:51], s79 offen offset:3072 lds
    ds_read_b64_tr_b16 v[224:225], v8 offset:24576
    ds_read_b64_tr_b16 v[226:227], v8 offset:26624
    ds_read_b64_tr_b16 v[220:221], v9 offset:24576
    ds_read_b64_tr_b16 v[222:223], v9 offset:26624
    ds_read_b64_tr_b16 v[216:217], v10 offset:24576
    ds_read_b64_tr_b16 v[218:219], v10 offset:26624
    ds_read_b64_tr_b16 v[212:213], v11 offset:24576
    ds_read_b64_tr_b16 v[214:215], v11 offset:26624
    s_waitcnt lgkmcnt(0)
    s_bfe_u32 s79, s35, 0x40004
    s_mul_i32 s79, s79, 131072
    s_add_u32 s79, s79, s3
    s_add_u32 m0, s78, 24576
    s_nop 0
    buffer_load_dwordx4 v4, s[48:51], s79 offen offset:0 lds
    buffer_load_dwordx4 v5, s[48:51], s79 offen offset:1024 lds
    buffer_load_dwordx4 v6, s[48:51], s79 offen offset:2048 lds
    buffer_load_dwordx4 v7, s[48:51], s79 offen offset:3072 lds
    s_waitcnt vmcnt(24)
    ds_read_b64_tr_b16 v[208:209], v8 offset:0
    ds_read_b64_tr_b16 v[210:211], v8 offset:2048
    ds_read_b64_tr_b16 v[204:205], v9 offset:0
    ds_read_b64_tr_b16 v[206:207], v9 offset:2048
    ds_read_b64_tr_b16 v[200:201], v10 offset:0
    ds_read_b64_tr_b16 v[202:203], v10 offset:2048
    ds_read_b64_tr_b16 v[196:197], v11 offset:0
    ds_read_b64_tr_b16 v[198:199], v11 offset:2048
    s_waitcnt lgkmcnt(0)
    s_bfe_u32 s79, s35, 0x40008
    s_mul_i32 s79, s79, 131072
    s_add_u32 s79, s79, s3
    s_add_u32 m0, s78, 0
    s_nop 0
    buffer_load_dwordx4 v4, s[48:51], s79 offen offset:0 lds
    buffer_load_dwordx4 v5, s[48:51], s79 offen offset:1024 lds
    buffer_load_dwordx4 v6, s[48:51], s79 offen offset:2048 lds
    buffer_load_dwordx4 v7, s[48:51], s79 offen offset:3072 lds
    v_min_u32 v14, 29, v0
    v_mul_u32_u24 v12, 43, v14
    v_lshrrev_b32 v12, 8, v12
    v_mul_u32_u24 v13, 18, v12
    v_add_u32 v12, v13, v14
    v_mul_u32_u24_e64 v12, 16, v12
    s_mul_i32 s70, s65, 120
    s_mul_i32 s71, s59, 6
    s_add_u32 s70, s70, s71
    s_mul_i32 s70, s70, 16
    s_add_u32 s70, s70, 0x30000
    s_mul_i32 s74, s65, 245760
    s_mul_i32 s75, s59, 61440
    s_add_u32 s74, s74, s75
    s_add_u32 s69, s74, 0x700000
    s_and_b32 s15, s65, 1
    s_lshl_b32 s71, s15, 10
    s_add_u32 s69, s69, s71
    s_mul_i32 s13, s15, -5120
    s_add_u32 s13, s13, 4096
    s_bfe_u32 s74, s34, 0x40000
    s_mul_i32 s74, s74, 5120
    s_add_u32 s74, s74, s69
    s_add_u32 s75, s74, s13
    buffer_load_dwordx2 v[14:15], v12, s[40:43], s70 offen sc1
    s_and_b32 s15, s65, 1
    v_and_b32 v16, 15, v0
    v_lshrrev_b32 v17, 4, v0
    s_lshl_b32 s28, s66, 6
    s_lshl_b32 s29, s59, 4
    s_add_u32 s28, s28, s29
    v_add_u32 v18, s28, v16
    v_mul_u32_u24 v19, 1280, v18
    s_mul_i32 s29, s65, 160
    v_add_u32_e64 v19, s29, v19
    v_lshl_add_u32 v159, v17, 3, v19
    s_lshl_b32 s29, s15, 5
    v_add_u32 v19, s29, v19
    s_xor_b32 s29, s15, 1
    s_lshl_b32 s29, s29, 7
    v_add_u32 v159, s29, v159
    v_and_b32 v16, 1, v17
    v_lshl_add_u32 v19, v16, 5, v19
    v_lshrrev_b32_e64 v17, 1, v17
    v_lshl_add_u32 v80, v17, 4, v19
    buffer_load_dwordx4 v[148:151], v80, s[36:39], 0 offen offset:0
    buffer_load_dwordx4 v[152:155], v80, s[36:39], 0 offen offset:64
    buffer_load_dwordx2 v[156:157], v159, s[36:39], 0 offen
    v_lshlrev_b32_e64 v18, 1, v18
    global_load_ushort v158, v18, s[26:27]
    s_waitcnt vmcnt(29)
    ds_read_b64_tr_b16 v[192:193], v8 offset:4096
    ds_read_b64_tr_b16 v[194:195], v8 offset:6144
    ds_read_b64_tr_b16 v[188:189], v9 offset:4096
    ds_read_b64_tr_b16 v[190:191], v9 offset:6144
    ds_read_b64_tr_b16 v[184:185], v10 offset:4096
    ds_read_b64_tr_b16 v[186:187], v10 offset:6144
    ds_read_b64_tr_b16 v[180:181], v11 offset:4096
    ds_read_b64_tr_b16 v[182:183], v11 offset:6144
    s_waitcnt lgkmcnt(0)
    s_bfe_u32 s79, s35, 0x4000c
    s_mul_i32 s79, s79, 131072
    s_add_u32 s79, s79, s3
    s_add_u32 m0, s78, 4096
    s_nop 0
    buffer_load_dwordx4 v4, s[48:51], s79 offen offset:0 lds
    buffer_load_dwordx4 v5, s[48:51], s79 offen offset:1024 lds
    buffer_load_dwordx4 v6, s[48:51], s79 offen offset:2048 lds
    buffer_load_dwordx4 v7, s[48:51], s79 offen offset:3072 lds
    s_waitcnt vmcnt(8)
    v_cmp_ne_u64 vcc, s[56:57], v[14:15]
    s_cbranch_vccz L_pf_10
    s_mov_b32 s68, 0
L_pl_11:
    buffer_load_dwordx2 v[14:15], v12, s[40:43], s70 offen sc1
    s_waitcnt vmcnt(0)
    v_cmp_ne_u64_e64 vcc, s[56:57], v[14:15]
    s_nop 0
    s_and_b64 exec, exec, vcc
    s_cbranch_scc0 L_pld_12
    s_sleep 1
    s_add_u32 s68, s68, 1
    s_cmp_lt_u32 s68, 0x40000
    s_cbranch_scc1 L_pl_11
L_pld_12:
    s_mov_b64 exec, -1
L_pf_10:
    s_setprio 0
    buffer_load_dwordx4 v[96:99], v2, s[40:43], s74 offen offset:0 sc1
    buffer_load_dwordx4 v[100:103], v2, s[40:43], s74 offen offset:1024 sc1
    buffer_load_dwordx4 v[104:107], v2, s[40:43], s74 offen offset:2048 sc1
    buffer_load_dwordx4 v[108:111], v2, s[40:43], s74 offen offset:3072 sc1
    buffer_load_dwordx4 v[112:115], v2, s[40:43], s75 offen offset:0 sc1
    s_bfe_u32 s74, s34, 0x40004
    s_mul_i32 s74, s74, 5120
    s_add_u32 s74, s74, s69
    s_add_u32 s75, s74, s13
    buffer_load_dwordx4 v[116:119], v2, s[40:43], s74 offen offset:0 sc1
    buffer_load_dwordx4 v[120:123], v2, s[40:43], s74 offen offset:1024 sc1
    buffer_load_dwordx4 v[124:127], v2, s[40:43], s74 offen offset:2048 sc1
    buffer_load_dwordx4 v[128:131], v2, s[40:43], s74 offen offset:3072 sc1
    s_waitcnt vmcnt(8)
    v_mfma_f32_16x16x32_bf16 v[16:19], v[96:99], v[240:243], 0
    v_mfma_f32_16x16x32_bf16 v[20:23], v[96:99], v[252:255], 0
    v_mfma_f32_16x16x32_bf16 v[24:27], v[96:99], v[248:251], 0
    v_mfma_f32_16x16x32_bf16 v[12:15], v[96:99], v[136:139], 0
    s_waitcnt vmcnt(7)
    v_mfma_f32_16x16x32_bf16 v[32:35], v[100:103], v[240:243], 0
    buffer_load_dwordx4 v[132:135], v2, s[40:43], s75 offen offset:0 sc1
    v_mfma_f32_16x16x32_bf16 v[36:39], v[100:103], v[252:255], 0
    v_mfma_f32_16x16x32_bf16 v[40:43], v[100:103], v[248:251], 0
    v_mfma_f32_16x16x32_bf16 v[28:31], v[100:103], v[136:139], 0
    s_waitcnt vmcnt(7)
    v_mfma_f32_16x16x32_bf16 v[48:51], v[104:107], v[240:243], 0
    s_bfe_u32 s74, s34, 0x40008
    s_mul_i32 s74, s74, 5120
    v_mfma_f32_16x16x32_bf16 v[52:55], v[104:107], v[252:255], 0
    s_add_u32 s74, s74, s69
    s_add_u32 s75, s74, s13
    v_mfma_f32_16x16x32_bf16 v[56:59], v[104:107], v[248:251], 0
    buffer_load_dwordx4 v[140:143], v2, s[40:43], s74 offen offset:0 sc1
    v_mfma_f32_16x16x32_bf16 v[44:47], v[104:107], v[136:139], 0
    s_waitcnt vmcnt(7)
    v_mfma_f32_16x16x32_bf16 v[64:67], v[108:111], v[240:243], 0
    buffer_load_dwordx4 v[144:147], v2, s[40:43], s74 offen offset:1024 sc1
    v_mfma_f32_16x16x32_bf16 v[68:71], v[108:111], v[252:255], 0
    v_mfma_f32_16x16x32_bf16 v[72:75], v[108:111], v[248:251], 0
    v_mfma_f32_16x16x32_bf16 v[60:63], v[108:111], v[136:139], 0
    s_waitcnt vmcnt(7)
    v_mfma_f32_16x16x32_bf16 v[84:87], v[112:115], v[240:243], 0
    buffer_load_dwordx4 v[160:163], v2, s[40:43], s74 offen offset:2048 sc1
    v_mfma_f32_16x16x32_bf16 v[88:91], v[112:115], v[252:255], 0
    v_mfma_f32_16x16x32_bf16 v[92:95], v[112:115], v[248:251], 0
    v_mfma_f32_16x16x32_bf16 v[76:79], v[112:115], v[136:139], 0
    s_waitcnt vmcnt(7)
    v_mfma_f32_16x16x32_bf16 v[16:19], v[116:119], v[236:239], v[16:19]
    buffer_load_dwordx4 v[164:167], v2, s[40:43], s74 offen offset:3072 sc1
    v_mfma_f32_16x16x32_bf16 v[20:23], v[116:119], v[232:235], v[20:23]
    ds_read_b64_tr_b16 v[168:169], v8 offset:8192
    ds_read_b64_tr_b16 v[170:171], v8 offset:10240
    v_mfma_f32_16x16x32_bf16 v[24:27], v[116:119], v[228:231], v[24:27]
    ds_read_b64_tr_b16 v[172:173], v9 offset:8192
    ds_read_b64_tr_b16 v[174:175], v9 offset:10240
    v_mfma_f32_16x16x32_bf16 v[12:15], v[116:119], v[244:247], v[12:15]
    ds_read_b64_tr_b16 v[176:177], v10 offset:8192
    ds_read_b64_tr_b16 v[178:179], v10 offset:10240
    s_waitcnt vmcnt(7)
    v_mfma_f32_16x16x32_bf16 v[32:35], v[120:123], v[236:239], v[32:35]
    buffer_load_dwordx4 v[100:103], v2, s[40:43], s75 offen offset:0 sc1
    ds_read_b64_tr_b16 v[96:97], v11 offset:8192
    v_mfma_f32_16x16x32_bf16 v[36:39], v[120:123], v[232:235], v[36:39]
    ds_read_b64_tr_b16 v[98:99], v11 offset:10240
    v_mfma_f32_16x16x32_bf16 v[40:43], v[120:123], v[228:231], v[40:43]
    v_mfma_f32_16x16x32_bf16 v[28:31], v[120:123], v[244:247], v[28:31]
    s_waitcnt vmcnt(7)
    v_mfma_f32_16x16x32_bf16 v[48:51], v[124:127], v[236:239], v[48:51]
    s_bfe_u32 s74, s34, 0x4000c
    s_mul_i32 s74, s74, 5120
    v_mfma_f32_16x16x32_bf16 v[52:55], v[124:127], v[232:235], v[52:55]
    s_add_u32 s74, s74, s69
    s_add_u32 s75, s74, s13
    v_mfma_f32_16x16x32_bf16 v[56:59], v[124:127], v[228:231], v[56:59]
    buffer_load_dwordx4 v[104:107], v2, s[40:43], s74 offen offset:0 sc1
    v_mfma_f32_16x16x32_bf16 v[44:47], v[124:127], v[244:247], v[44:47]
    s_waitcnt vmcnt(7)
    v_mfma_f32_16x16x32_bf16 v[64:67], v[128:131], v[236:239], v[64:67]
    buffer_load_dwordx4 v[108:111], v2, s[40:43], s74 offen offset:1024 sc1
    v_mfma_f32_16x16x32_bf16 v[68:71], v[128:131], v[232:235], v[68:71]
    v_mfma_f32_16x16x32_bf16 v[72:75], v[128:131], v[228:231], v[72:75]
    v_mfma_f32_16x16x32_bf16 v[60:63], v[128:131], v[244:247], v[60:63]
    s_waitcnt vmcnt(7)
    v_mfma_f32_16x16x32_bf16 v[84:87], v[132:135], v[236:239], v[84:87]
    buffer_load_dwordx4 v[112:115], v2, s[40:43], s74 offen offset:2048 sc1
    v_mfma_f32_16x16x32_bf16 v[88:91], v[132:135], v[232:235], v[88:91]
    v_mfma_f32_16x16x32_bf16 v[92:95], v[132:135], v[228:231], v[92:95]
    v_mfma_f32_16x16x32_bf16 v[76:79], v[132:135], v[244:247], v[76:79]
    s_waitcnt vmcnt(7)
    v_mfma_f32_16x16x32_bf16 v[16:19], v[140:143], v[220:223], v[16:19]
    buffer_load_dwordx4 v[136:139], v2, s[40:43], s74 offen offset:3072 sc1
    v_mfma_f32_16x16x32_bf16 v[20:23], v[140:143], v[216:219], v[20:23]
    ds_read_b64_tr_b16 v[240:241], v8 offset:12288
    ds_read_b64_tr_b16 v[242:243], v8 offset:14336
    v_mfma_f32_16x16x32_bf16 v[24:27], v[140:143], v[212:215], v[24:27]
    ds_read_b64_tr_b16 v[252:253], v9 offset:12288
    ds_read_b64_tr_b16 v[254:255], v9 offset:14336
    v_mfma_f32_16x16x32_bf16 v[12:15], v[140:143], v[224:227], v[12:15]
    ds_read_b64_tr_b16 v[248:249], v10 offset:12288
    ds_read_b64_tr_b16 v[250:251], v10 offset:14336
    s_waitcnt vmcnt(7)
    v_mfma_f32_16x16x32_bf16 v[32:35], v[144:147], v[220:223], v[32:35]
    buffer_load_dwordx4 v[120:123], v2, s[40:43], s75 offen offset:0 sc1
    ds_read_b64_tr_b16 v[116:117], v11 offset:12288
    v_mfma_f32_16x16x32_bf16 v[36:39], v[144:147], v[216:219], v[36:39]
    ds_read_b64_tr_b16 v[118:119], v11 offset:14336
    v_permlane16_swap_b32 v148, v150
    v_mfma_f32_16x16x32_bf16 v[40:43], v[144:147], v[212:215], v[40:43]
    v_permlane16_swap_b32 v149, v151
    v_permlane16_swap_b32 v152, v154
    v_mfma_f32_16x16x32_bf16 v[28:31], v[144:147], v[224:227], v[28:31]
    v_permlane16_swap_b32 v153, v155
    s_waitcnt vmcnt(7)
    v_mfma_f32_16x16x32_bf16 v[48:51], v[160:163], v[220:223], v[48:51]
    s_bfe_u32 s74, s34, 0x40010
    s_mul_i32 s74, s74, 5120
    v_mfma_f32_16x16x32_bf16 v[52:55], v[160:163], v[216:219], v[52:55]
    s_add_u32 s74, s74, s69
    s_add_u32 s75, s74, s13
    v_mfma_f32_16x16x32_bf16 v[56:59], v[160:163], v[212:215], v[56:59]
    buffer_load_dwordx4 v[124:127], v2, s[40:43], s74 offen offset:0 sc1
    v_mfma_f32_16x16x32_bf16 v[44:47], v[160:163], v[224:227], v[44:47]
    s_waitcnt vmcnt(7)
    v_mfma_f32_16x16x32_bf16 v[64:67], v[164:167], v[220:223], v[64:67]
    buffer_load_dwordx4 v[128:131], v2, s[40:43], s74 offen offset:1024 sc1
    v_mfma_f32_16x16x32_bf16 v[68:71], v[164:167], v[216:219], v[68:71]
    v_mfma_f32_16x16x32_bf16 v[72:75], v[164:167], v[212:215], v[72:75]
    v_mfma_f32_16x16x32_bf16 v[60:63], v[164:167], v[224:227], v[60:63]
    s_waitcnt vmcnt(7)
    v_mfma_f32_16x16x32_bf16 v[84:87], v[100:103], v[220:223], v[84:87]
    buffer_load_dwordx4 v[132:135], v2, s[40:43], s74 offen offset:2048 sc1
    v_mfma_f32_16x16x32_bf16 v[88:91], v[100:103], v[216:219], v[88:91]
    v_mfma_f32_16x16x32_bf16 v[92:95], v[100:103], v[212:215], v[92:95]
    v_mfma_f32_16x16x32_bf16 v[76:79], v[100:103], v[224:227], v[76:79]
    s_waitcnt vmcnt(7)
    v_mfma_f32_16x16x32_bf16 v[16:19], v[104:107], v[204:207], v[16:19]
    buffer_load_dwordx4 v[244:247], v2, s[40:43], s74 offen offset:3072 sc1
    v_mfma_f32_16x16x32_bf16 v[20:23], v[104:107], v[200:203], v[20:23]
    ds_read_b64_tr_b16 v[236:237], v8 offset:16384
    ds_read_b64_tr_b16 v[238:239], v8 offset:18432
    v_mfma_f32_16x16x32_bf16 v[24:27], v[104:107], v[196:199], v[24:27]
    ds_read_b64_tr_b16 v[232:233], v9 offset:16384
    ds_read_b64_tr_b16 v[234:235], v9 offset:18432
    v_mfma_f32_16x16x32_bf16 v[12:15], v[104:107], v[208:211], v[12:15]
    ds_read_b64_tr_b16 v[228:229], v10 offset:16384
    ds_read_b64_tr_b16 v[230:231], v10 offset:18432
    s_waitcnt vmcnt(7)
    v_mfma_f32_16x16x32_bf16 v[32:35], v[108:111], v[204:207], v[32:35]
    buffer_load_dwordx4 v[144:147], v2, s[40:43], s75 offen offset:0 sc1
    ds_read_b64_tr_b16 v[140:141], v11 offset:16384
    v_mfma_f32_16x16x32_bf16 v[36:39], v[108:111], v[200:203], v[36:39]
    ds_read_b64_tr_b16 v[142:143], v11 offset:18432
    v_mfma_f32_16x16x32_bf16 v[40:43], v[108:111], v[196:199], v[40:43]
    v_mfma_f32_16x16x32_bf16 v[28:31], v[108:111], v[208:211], v[28:31]
    s_waitcnt vmcnt(7)
    v_mfma_f32_16x16x32_bf16 v[48:51], v[112:115], v[204:207], v[48:51]
    s_bfe_u32 s74, s34, 0x40014
    s_mul_i32 s74, s74, 5120
    v_mfma_f32_16x16x32_bf16 v[52:55], v[112:115], v[200:203], v[52:55]
    s_add_u32 s74, s74, s69
    s_add_u32 s75, s74, s13
    v_mfma_f32_16x16x32_bf16 v[56:59], v[112:115], v[196:199], v[56:59]
    buffer_load_dwordx4 v[160:163], v2, s[40:43], s74 offen offset:0 sc1
    v_mfma_f32_16x16x32_bf16 v[44:47], v[112:115], v[208:211], v[44:47]
    s_waitcnt vmcnt(7)
    v_mfma_f32_16x16x32_bf16 v[64:67], v[136:139], v[204:207], v[64:67]
    buffer_load_dwordx4 v[164:167], v2, s[40:43], s74 offen offset:1024 sc1
    v_mfma_f32_16x16x32_bf16 v[68:71], v[136:139], v[200:203], v[68:71]
    v_mfma_f32_16x16x32_bf16 v[72:75], v[136:139], v[196:199], v[72:75]
    v_mfma_f32_16x16x32_bf16 v[60:63], v[136:139], v[208:211], v[60:63]
    s_waitcnt vmcnt(7)
    v_mfma_f32_16x16x32_bf16 v[84:87], v[120:123], v[204:207], v[84:87]
    buffer_load_dwordx4 v[100:103], v2, s[40:43], s74 offen offset:2048 sc1
    v_mfma_f32_16x16x32_bf16 v[88:91], v[120:123], v[200:203], v[88:91]
    v_mfma_f32_16x16x32_bf16 v[92:95], v[120:123], v[196:199], v[92:95]
    v_mfma_f32_16x16x32_bf16 v[76:79], v[120:123], v[208:211], v[76:79]
    s_waitcnt vmcnt(7)
    v_mfma_f32_16x16x32_bf16 v[16:19], v[124:127], v[188:191], v[16:19]
    buffer_load_dwordx4 v[224:227], v2, s[40:43], s74 offen offset:3072 sc1
    v_mfma_f32_16x16x32_bf16 v[20:23], v[124:127], v[184:187], v[20:23]
    ds_read_b64_tr_b16 v[220:221], v8 offset:20480
    ds_read_b64_tr_b16 v[222:223], v8 offset:22528
    v_mfma_f32_16x16x32_bf16 v[24:27], v[124:127], v[180:183], v[24:27]
    ds_read_b64_tr_b16 v[216:217], v9 offset:20480
    ds_read_b64_tr_b16 v[218:219], v9 offset:22528
    v_mfma_f32_16x16x32_bf16 v[12:15], v[124:127], v[192:195], v[12:15]
    ds_read_b64_tr_b16 v[212:213], v10 offset:20480
    ds_read_b64_tr_b16 v[214:215], v10 offset:22528
    s_waitcnt vmcnt(7)
    v_mfma_f32_16x16x32_bf16 v[32:35], v[128:131], v[188:191], v[32:35]
    buffer_load_dwordx4 v[108:111], v2, s[40:43], s75 offen offset:0 sc1
    ds_read_b64_tr_b16 v[104:105], v11 offset:20480
    v_mfma_f32_16x16x32_bf16 v[36:39], v[128:131], v[184:187], v[36:39]
    ds_read_b64_tr_b16 v[106:107], v11 offset:22528
    v_mfma_f32_16x16x32_bf16 v[40:43], v[128:131], v[180:183], v[40:43]
    v_mfma_f32_16x16x32_bf16 v[28:31], v[128:131], v[192:195], v[28:31]
    s_waitcnt vmcnt(7)
    v_mfma_f32_16x16x32_bf16 v[48:51], v[132:135], v[188:191], v[48:51]
    s_bfe_u32 s74, s34, 0x40018
    s_mul_i32 s74, s74, 5120
    v_mfma_f32_16x16x32_bf16 v[52:55], v[132:135], v[184:187], v[52:55]
    s_add_u32 s74, s74, s69
    s_add_u32 s75, s74, s13
    v_mfma_f32_16x16x32_bf16 v[56:59], v[132:135], v[180:183], v[56:59]
    buffer_load_dwordx4 v[112:115], v2, s[40:43], s74 offen offset:0 sc1
    v_mfma_f32_16x16x32_bf16 v[44:47], v[132:135], v[192:195], v[44:47]
    s_waitcnt vmcnt(7)
    v_mfma_f32_16x16x32_bf16 v[64:67], v[244:247], v[188:191], v[64:67]
    buffer_load_dwordx4 v[136:139], v2, s[40:43], s74 offen offset:1024 sc1
    v_mfma_f32_16x16x32_bf16 v[68:71], v[244:247], v[184:187], v[68:71]
    v_mfma_f32_16x16x32_bf16 v[72:75], v[244:247], v[180:183], v[72:75]
    v_mfma_f32_16x16x32_bf16 v[60:63], v[244:247], v[192:195], v[60:63]
    s_waitcnt vmcnt(7)
    v_mfma_f32_16x16x32_bf16 v[84:87], v[144:147], v[188:191], v[84:87]
    buffer_load_dwordx4 v[120:123], v2, s[40:43], s74 offen offset:2048 sc1
    v_mfma_f32_16x16x32_bf16 v[88:91], v[144:147], v[184:187], v[88:91]
    v_mfma_f32_16x16x32_bf16 v[92:95], v[144:147], v[180:183], v[92:95]
    v_mfma_f32_16x16x32_bf16 v[76:79], v[144:147], v[192:195], v[76:79]
    s_waitcnt lgkmcnt(15)
    s_waitcnt vmcnt(7)
    v_mfma_f32_16x16x32_bf16 v[16:19], v[160:163], v[172:175], v[16:19]
    buffer_load_dwordx4 v[208:211], v2, s[40:43], s74 offen offset:3072 sc1
    v_mfma_f32_16x16x32_bf16 v[20:23], v[160:163], v[176:179], v[20:23]
    ds_read_b64_tr_b16 v[204:205], v8 offset:24576
    ds_read_b64_tr_b16 v[206:207], v8 offset:26624
    v_mfma_f32_16x16x32_bf16 v[24:27], v[160:163], v[96:99], v[24:27]
    ds_read_b64_tr_b16 v[200:201], v9 offset:24576
    ds_read_b64_tr_b16 v[202:203], v9 offset:26624
    v_mfma_f32_16x16x32_bf16 v[12:15], v[160:163], v[168:171], v[12:15]
    ds_read_b64_tr_b16 v[196:197], v10 offset:24576
    ds_read_b64_tr_b16 v[198:199], v10 offset:26624
    s_waitcnt vmcnt(7)
    v_mfma_f32_16x16x32_bf16 v[32:35], v[164:167], v[172:175], v[32:35]
    buffer_load_dwordx4 v[128:131], v2, s[40:43], s75 offen offset:0 sc1
    ds_read_b64_tr_b16 v[124:125], v11 offset:24576
    v_mfma_f32_16x16x32_bf16 v[36:39], v[164:167], v[176:179], v[36:39]
    ds_read_b64_tr_b16 v[126:127], v11 offset:26624
    v_mfma_f32_16x16x32_bf16 v[40:43], v[164:167], v[96:99], v[40:43]
    v_mfma_f32_16x16x32_bf16 v[28:31], v[164:167], v[168:171], v[28:31]
    s_waitcnt vmcnt(7)
    v_mfma_f32_16x16x32_bf16 v[48:51], v[100:103], v[172:175], v[48:51]
    s_bfe_u32 s74, s34, 0x4001c
    s_mul_i32 s74, s74, 5120
    v_mfma_f32_16x16x32_bf16 v[52:55], v[100:103], v[176:179], v[52:55]
    s_add_u32 s74, s74, s69
    s_add_u32 s75, s74, s13
    v_mfma_f32_16x16x32_bf16 v[56:59], v[100:103], v[96:99], v[56:59]
    buffer_load_dwordx4 v[132:135], v2, s[40:43], s74 offen offset:0 sc1
    v_mfma_f32_16x16x32_bf16 v[44:47], v[100:103], v[168:171], v[44:47]
    s_waitcnt vmcnt(7)
    v_mfma_f32_16x16x32_bf16 v[64:67], v[224:227], v[172:175], v[64:67]
    buffer_load_dwordx4 v[244:247], v2, s[40:43], s74 offen offset:1024 sc1
    v_mfma_f32_16x16x32_bf16 v[68:71], v[224:227], v[176:179], v[68:71]
    v_mfma_f32_16x16x32_bf16 v[72:75], v[224:227], v[96:99], v[72:75]
    v_mfma_f32_16x16x32_bf16 v[60:63], v[224:227], v[168:171], v[60:63]
    s_waitcnt vmcnt(7)
    v_mfma_f32_16x16x32_bf16 v[84:87], v[108:111], v[172:175], v[84:87]
    buffer_load_dwordx4 v[144:147], v2, s[40:43], s74 offen offset:2048 sc1
    v_mfma_f32_16x16x32_bf16 v[88:91], v[108:111], v[176:179], v[88:91]
    v_mfma_f32_16x16x32_bf16 v[92:95], v[108:111], v[96:99], v[92:95]
    v_mfma_f32_16x16x32_bf16 v[76:79], v[108:111], v[168:171], v[76:79]
    s_waitcnt vmcnt(7)
    v_mfma_f32_16x16x32_bf16 v[16:19], v[112:115], v[252:255], v[16:19]
    buffer_load_dwordx4 v[192:195], v2, s[40:43], s74 offen offset:3072 sc1
    v_mfma_f32_16x16x32_bf16 v[20:23], v[112:115], v[248:251], v[20:23]
    ds_read_b64_tr_b16 v[188:189], v8 offset:0
    ds_read_b64_tr_b16 v[190:191], v8 offset:2048
    v_mfma_f32_16x16x32_bf16 v[24:27], v[112:115], v[116:119], v[24:27]
    ds_read_b64_tr_b16 v[184:185], v9 offset:0
    ds_read_b64_tr_b16 v[186:187], v9 offset:2048
    v_mfma_f32_16x16x32_bf16 v[12:15], v[112:115], v[240:243], v[12:15]
    ds_read_b64_tr_b16 v[180:181], v10 offset:0
    ds_read_b64_tr_b16 v[182:183], v10 offset:2048
    s_waitcnt vmcnt(7)
    v_mfma_f32_16x16x32_bf16 v[32:35], v[136:139], v[252:255], v[32:35]
    buffer_load_dwordx4 v[164:167], v2, s[40:43], s75 offen offset:0 sc1
    ds_read_b64_tr_b16 v[160:161], v11 offset:0
    v_mfma_f32_16x16x32_bf16 v[36:39], v[136:139], v[248:251], v[36:39]
    ds_read_b64_tr_b16 v[162:163], v11 offset:2048
    v_mfma_f32_16x16x32_bf16 v[40:43], v[136:139], v[116:119], v[40:43]
    v_mfma_f32_16x16x32_bf16 v[28:31], v[136:139], v[240:243], v[28:31]
    s_waitcnt vmcnt(7)
    v_mfma_f32_16x16x32_bf16 v[48:51], v[120:123], v[252:255], v[48:51]
    s_bfe_u32 s74, s35, 0x40000
    s_mul_i32 s74, s74, 5120
    v_mfma_f32_16x16x32_bf16 v[52:55], v[120:123], v[248:251], v[52:55]
    s_add_u32 s74, s74, s69
    s_add_u32 s75, s74, s13
    v_mfma_f32_16x16x32_bf16 v[56:59], v[120:123], v[116:119], v[56:59]
    buffer_load_dwordx4 v[100:103], v2, s[40:43], s74 offen offset:0 sc1
    v_mfma_f32_16x16x32_bf16 v[44:47], v[120:123], v[240:243], v[44:47]
    s_waitcnt vmcnt(7)
    v_mfma_f32_16x16x32_bf16 v[64:67], v[208:211], v[252:255], v[64:67]
    buffer_load_dwordx4 v[224:227], v2, s[40:43], s74 offen offset:1024 sc1
    v_mfma_f32_16x16x32_bf16 v[68:71], v[208:211], v[248:251], v[68:71]
    v_mfma_f32_16x16x32_bf16 v[72:75], v[208:211], v[116:119], v[72:75]
    v_mfma_f32_16x16x32_bf16 v[60:63], v[208:211], v[240:243], v[60:63]
    s_waitcnt vmcnt(7)
    v_mfma_f32_16x16x32_bf16 v[84:87], v[128:131], v[252:255], v[84:87]
    buffer_load_dwordx4 v[108:111], v2, s[40:43], s74 offen offset:2048 sc1
    v_mfma_f32_16x16x32_bf16 v[88:91], v[128:131], v[248:251], v[88:91]
    v_mfma_f32_16x16x32_bf16 v[92:95], v[128:131], v[116:119], v[92:95]
    v_mfma_f32_16x16x32_bf16 v[76:79], v[128:131], v[240:243], v[76:79]
    s_waitcnt lgkmcnt(15)
    s_waitcnt vmcnt(7)
    v_mfma_f32_16x16x32_bf16 v[16:19], v[132:135], v[232:235], v[16:19]
    buffer_load_dwordx4 v[168:171], v2, s[40:43], s74 offen offset:3072 sc1
    v_mfma_f32_16x16x32_bf16 v[20:23], v[132:135], v[228:231], v[20:23]
    ds_read_b64_tr_b16 v[172:173], v8 offset:4096
    ds_read_b64_tr_b16 v[174:175], v8 offset:6144
    v_mfma_f32_16x16x32_bf16 v[24:27], v[132:135], v[140:143], v[24:27]
    ds_read_b64_tr_b16 v[176:177], v9 offset:4096
    ds_read_b64_tr_b16 v[178:179], v9 offset:6144
    v_mfma_f32_16x16x32_bf16 v[12:15], v[132:135], v[236:239], v[12:15]
    ds_read_b64_tr_b16 v[96:97], v10 offset:4096
    ds_read_b64_tr_b16 v[98:99], v10 offset:6144
    s_waitcnt vmcnt(7)
    v_mfma_f32_16x16x32_bf16 v[32:35], v[244:247], v[232:235], v[32:35]
    buffer_load_dwordx4 v[136:139], v2, s[40:43], s75 offen offset:0 sc1
    ds_read_b64_tr_b16 v[112:113], v11 offset:4096
    v_mfma_f32_16x16x32_bf16 v[36:39], v[244:247], v[228:231], v[36:39]
    ds_read_b64_tr_b16 v[114:115], v11 offset:6144
    v_mfma_f32_16x16x32_bf16 v[40:43], v[244:247], v[140:143], v[40:43]
    v_mfma_f32_16x16x32_bf16 v[28:31], v[244:247], v[236:239], v[28:31]
    s_waitcnt vmcnt(7)
    v_mfma_f32_16x16x32_bf16 v[48:51], v[144:147], v[232:235], v[48:51]
    s_bfe_u32 s74, s35, 0x40004
    s_mul_i32 s74, s74, 5120
    v_mfma_f32_16x16x32_bf16 v[52:55], v[144:147], v[228:231], v[52:55]
    s_add_u32 s74, s74, s69
    s_add_u32 s75, s74, s13
    v_mfma_f32_16x16x32_bf16 v[56:59], v[144:147], v[140:143], v[56:59]
    buffer_load_dwordx4 v[120:123], v2, s[40:43], s74 offen offset:0 sc1
    v_mfma_f32_16x16x32_bf16 v[44:47], v[144:147], v[236:239], v[44:47]
    s_waitcnt vmcnt(7)
    v_mfma_f32_16x16x32_bf16 v[64:67], v[192:195], v[232:235], v[64:67]
    s_bfe_u32 s8, s35, 0x40008
    s_mul_i32 s8, s8, 5120
    v_mfma_f32_16x16x32_bf16 v[68:71], v[192:195], v[228:231], v[68:71]
    s_add_u32 s8, s8, s69
    s_add_u32 s9, s8, s13
    v_mfma_f32_16x16x32_bf16 v[72:75], v[192:195], v[140:143], v[72:75]
    buffer_load_dwordx4 v[208:211], v2, s[40:43], s8 offen offset:0 sc1
    v_mfma_f32_16x16x32_bf16 v[60:63], v[192:195], v[236:239], v[60:63]
    s_waitcnt vmcnt(7)
    v_mfma_f32_16x16x32_bf16 v[84:87], v[164:167], v[232:235], v[84:87]
    s_bfe_u32 s10, s35, 0x4000c
    s_mul_i32 s10, s10, 5120
    v_mfma_f32_16x16x32_bf16 v[88:91], v[164:167], v[228:231], v[88:91]
    s_add_u32 s10, s10, s69
    s_add_u32 s11, s10, s13
    v_mfma_f32_16x16x32_bf16 v[92:95], v[164:167], v[140:143], v[92:95]
    buffer_load_dwordx4 v[128:131], v2, s[40:43], s10 offen offset:0 sc1
    v_mfma_f32_16x16x32_bf16 v[76:79], v[164:167], v[236:239], v[76:79]
    s_waitcnt vmcnt(7)
    v_mfma_f32_16x16x32_bf16 v[16:19], v[100:103], v[216:219], v[16:19]
    buffer_load_dwordx4 v[240:243], v2, s[40:43], s74 offen offset:1024 sc1
    v_mfma_f32_16x16x32_bf16 v[20:23], v[100:103], v[212:215], v[20:23]
    v_add_u32 v252, s78, v2
    s_xor_b32 s16, s59, 1
    v_mfma_f32_16x16x32_bf16 v[24:27], v[100:103], v[104:107], v[24:27]
    s_mul_i32 s16, s16, 28672
    s_add_u32 s16, s16, 46336
    v_mfma_f32_16x16x32_bf16 v[12:15], v[100:103], v[220:223], v[12:15]
    v_add_u32_e64 v248, s16, v2
    s_xor_b32 s16, s59, 2
    s_waitcnt vmcnt(7)
    v_mfma_f32_16x16x32_bf16 v[32:35], v[224:227], v[216:219], v[32:35]
    buffer_load_dwordx4 v[116:119], v2, s[40:43], s8 offen offset:1024 sc1
    s_mul_i32 s16, s16, 28672
    v_mfma_f32_16x16x32_bf16 v[36:39], v[224:227], v[212:215], v[36:39]
    s_add_u32 s16, s16, 46336
    v_add_u32_e64 v249, s16, v2
    v_mfma_f32_16x16x32_bf16 v[40:43], v[224:227], v[104:107], v[40:43]
    s_xor_b32 s16, s59, 3
    s_mul_i32 s16, s16, 28672
    v_mfma_f32_16x16x32_bf16 v[28:31], v[224:227], v[220:223], v[28:31]
    s_add_u32 s16, s16, 46336
    v_add_u32_e64 v250, s16, v2
    s_waitcnt vmcnt(7)
    v_mfma_f32_16x16x32_bf16 v[48:51], v[108:111], v[216:219], v[48:51]
    buffer_load_dwordx4 v[132:135], v2, s[40:43], s10 offen offset:1024 sc1
    v_mfma_f32_16x16x32_bf16 v[52:55], v[108:111], v[212:215], v[52:55]
    v_mfma_f32_16x16x32_bf16 v[56:59], v[108:111], v[104:107], v[56:59]
    v_mfma_f32_16x16x32_bf16 v[44:47], v[108:111], v[220:223], v[44:47]
    s_waitcnt vmcnt(7)
    v_mfma_f32_16x16x32_bf16 v[64:67], v[168:171], v[216:219], v[64:67]
    buffer_load_dwordx4 v[244:247], v2, s[40:43], s74 offen offset:2048 sc1
    v_mfma_f32_16x16x32_bf16 v[68:71], v[168:171], v[212:215], v[68:71]
    v_mfma_f32_16x16x32_bf16 v[72:75], v[168:171], v[104:107], v[72:75]
    v_mfma_f32_16x16x32_bf16 v[60:63], v[168:171], v[220:223], v[60:63]
    s_waitcnt vmcnt(7)
    v_mfma_f32_16x16x32_bf16 v[84:87], v[136:139], v[216:219], v[84:87]
    buffer_load_dwordx4 v[144:147], v2, s[40:43], s8 offen offset:2048 sc1
    v_mfma_f32_16x16x32_bf16 v[88:91], v[136:139], v[212:215], v[88:91]
    v_mfma_f32_16x16x32_bf16 v[92:95], v[136:139], v[104:107], v[92:95]
    v_mfma_f32_16x16x32_bf16 v[76:79], v[136:139], v[220:223], v[76:79]
    s_waitcnt lgkmcnt(15)
    s_waitcnt vmcnt(7)
    v_mfma_f32_16x16x32_bf16 v[16:19], v[120:123], v[200:203], v[16:19]
    buffer_load_dwordx4 v[192:195], v2, s[40:43], s10 offen offset:2048 sc1
    v_mfma_f32_16x16x32_bf16 v[20:23], v[120:123], v[196:199], v[20:23]
    v_mfma_f32_16x16x32_bf16 v[24:27], v[120:123], v[124:127], v[24:27]
    v_mfma_f32_16x16x32_bf16 v[12:15], v[120:123], v[204:207], v[12:15]
    s_waitcnt lgkmcnt(8)
    s_waitcnt vmcnt(7)
    v_mfma_f32_16x16x32_bf16 v[16:19], v[208:211], v[184:187], v[16:19]
    buffer_load_dwordx4 v[164:167], v2, s[40:43], s74 offen offset:3072 sc1
    v_mfma_f32_16x16x32_bf16 v[20:23], v[208:211], v[180:183], v[20:23]
    v_mfma_f32_16x16x32_bf16 v[24:27], v[208:211], v[160:163], v[24:27]
    v_mfma_f32_16x16x32_bf16 v[12:15], v[208:211], v[188:191], v[12:15]
    s_waitcnt lgkmcnt(0)
    s_waitcnt vmcnt(7)
    v_mfma_f32_16x16x32_bf16 v[16:19], v[128:131], v[176:179], v[16:19]
    buffer_load_dwordx4 v[236:239], v2, s[40:43], s8 offen offset:3072 sc1
    v_mfma_f32_16x16x32_bf16 v[20:23], v[128:131], v[96:99], v[20:23]
    v_mfma_f32_16x16x32_bf16 v[24:27], v[128:131], v[112:115], v[24:27]
    v_mfma_f32_16x16x32_bf16 v[12:15], v[128:131], v[172:175], v[12:15]
    s_waitcnt vmcnt(7)
    v_mfma_f32_16x16x32_bf16 v[32:35], v[240:243], v[200:203], v[32:35]
    buffer_load_dwordx4 v[232:235], v2, s[40:43], s10 offen offset:3072 sc1
    v_mfma_f32_16x16x32_bf16 v[36:39], v[240:243], v[196:199], v[36:39]
    v_mfma_f32_16x16x32_bf16 v[40:43], v[240:243], v[124:127], v[40:43]
    v_mfma_f32_16x16x32_bf16 v[28:31], v[240:243], v[204:207], v[28:31]
    ds_write_b128 v252, v[16:19] offset:0
    ds_write_b128 v252, v[20:23] offset:5120
    s_waitcnt vmcnt(7)
    v_mfma_f32_16x16x32_bf16 v[32:35], v[116:119], v[184:187], v[32:35]
    buffer_load_dwordx4 v[228:231], v2, s[40:43], s75 offen offset:0 sc1
    ds_write_b128 v252, v[24:27] offset:10240
    v_mfma_f32_16x16x32_bf16 v[36:39], v[116:119], v[180:183], v[36:39]
    v_mfma_f32_16x16x32_bf16 v[40:43], v[116:119], v[160:163], v[40:43]
    v_mfma_f32_16x16x32_bf16 v[28:31], v[116:119], v[188:191], v[28:31]
    s_waitcnt vmcnt(7)
    v_mfma_f32_16x16x32_bf16 v[32:35], v[132:135], v[176:179], v[32:35]
    s_lshr_b32 s70, s66, 3
    s_mul_i32 s70, s70, 160
    v_mfma_f32_16x16x32_bf16 v[36:39], v[132:135], v[96:99], v[36:39]
    s_mul_i32 s71, s65, 20
    s_add_u32 s70, s70, s71
    v_mfma_f32_16x16x32_bf16 v[40:43], v[132:135], v[112:115], v[40:43]
    s_lshl_b32 s70, s70, 3
    s_add_u32 s70, s70, 0x50000
    v_mfma_f32_16x16x32_bf16 v[28:31], v[132:135], v[172:175], v[28:31]
    v_min_u32 v142, 19, v0
    v_lshlrev_b32 v142, 3, v142
    s_waitcnt vmcnt(6)
    v_mfma_f32_16x16x32_bf16 v[48:51], v[244:247], v[200:203], v[48:51]
    v_and_b32 v110, 15, v0
    v_lshrrev_b32 v111, 4, v0
    v_mfma_f32_16x16x32_bf16 v[52:55], v[244:247], v[196:199], v[52:55]
    v_lshlrev_b32_e64 v111, 14, v111
    v_lshl_add_u32 v110, v110, 3, v111
    v_mfma_f32_16x16x32_bf16 v[56:59], v[244:247], v[124:127], v[56:59]
    s_mul_i32 s72, s65, 327680
    s_lshl_b32 s71, s66, 9
    v_mfma_f32_16x16x32_bf16 v[44:47], v[244:247], v[204:207], v[44:47]
    s_add_u32 s72, s72, s71
    s_lshl_b32 s71, s59, 7
    s_waitcnt vmcnt(5)
    v_mfma_f32_16x16x32_bf16 v[48:51], v[144:147], v[184:187], v[48:51]
    s_add_u32 s72, s72, s71
    s_add_u32 s72, s72, 0xa00000
    v_mfma_f32_16x16x32_bf16 v[52:55], v[144:147], v[180:183], v[52:55]
    s_lshl_b32 s71, s15, 16
    s_add_u32 s72, s72, s71
    v_mfma_f32_16x16x32_bf16 v[56:59], v[144:147], v[160:163], v[56:59]
    s_lshl_b32 s14, s13, 6
    buffer_load_dwordx2 v[140:141], v142, s[40:43], s70 offen sc1
    v_mfma_f32_16x16x32_bf16 v[44:47], v[144:147], v[188:191], v[44:47]
    buffer_load_dwordx4 v[168:171], v2, s[40:43], s9 offen offset:0 sc1
    buffer_load_dwordx4 v[136:139], v2, s[40:43], s11 offen offset:0 sc1
    s_waitcnt vmcnt(7)
    v_mfma_f32_16x16x32_bf16 v[48:51], v[192:195], v[176:179], v[48:51]
    ds_write_b128 v252, v[32:35] offset:1024
    ds_write_b128 v252, v[36:39] offset:6144
    v_mfma_f32_16x16x32_bf16 v[52:55], v[192:195], v[96:99], v[52:55]
    ds_write_b128 v252, v[40:43] offset:11264
    v_mfma_f32_16x16x32_bf16 v[56:59], v[192:195], v[112:115], v[56:59]
    v_mfma_f32_16x16x32_bf16 v[44:47], v[192:195], v[172:175], v[44:47]
    s_waitcnt vmcnt(6)
    v_mfma_f32_16x16x32_bf16 v[64:67], v[164:167], v[200:203], v[64:67]
    v_mfma_f32_16x16x32_bf16 v[68:71], v[164:167], v[196:199], v[68:71]
    v_mfma_f32_16x16x32_bf16 v[72:75], v[164:167], v[124:127], v[72:75]
    v_mfma_f32_16x16x32_bf16 v[60:63], v[164:167], v[204:207], v[60:63]
    ds_write_b128 v252, v[48:51] offset:2048
    ds_write_b128 v252, v[52:55] offset:7168
    s_waitcnt vmcnt(5)
    v_mfma_f32_16x16x32_bf16 v[64:67], v[236:239], v[184:187], v[64:67]
    ds_write_b128 v252, v[56:59] offset:12288
    v_mfma_f32_16x16x32_bf16 v[68:71], v[236:239], v[180:183], v[68:71]
    v_mfma_f32_16x16x32_bf16 v[72:75], v[236:239], v[160:163], v[72:75]
    v_mfma_f32_16x16x32_bf16 v[60:63], v[236:239], v[188:191], v[60:63]
    s_waitcnt vmcnt(4)
    v_mfma_f32_16x16x32_bf16 v[64:67], v[232:235], v[176:179], v[64:67]
    v_mfma_f32_16x16x32_bf16 v[68:71], v[232:235], v[96:99], v[68:71]
    v_mfma_f32_16x16x32_bf16 v[72:75], v[232:235], v[112:115], v[72:75]
    v_mfma_f32_16x16x32_bf16 v[60:63], v[232:235], v[172:175], v[60:63]
    s_waitcnt vmcnt(3)
    v_mfma_f32_16x16x32_bf16 v[84:87], v[228:231], v[200:203], v[84:87]
    v_mfma_f32_16x16x32_bf16 v[88:91], v[228:231], v[196:199], v[88:91]
    v_mfma_f32_16x16x32_bf16 v[92:95], v[228:231], v[124:127], v[92:95]
    v_mfma_f32_16x16x32_bf16 v[76:79], v[228:231], v[204:207], v[76:79]
    ds_write_b128 v252, v[64:67] offset:3072
    ds_write_b128 v252, v[68:71] offset:8192
    s_waitcnt vmcnt(1)
    v_mfma_f32_16x16x32_bf16 v[84:87], v[168:171], v[184:187], v[84:87]
    ds_write_b128 v252, v[72:75] offset:13312
    v_mfma_f32_16x16x32_bf16 v[88:91], v[168:171], v[180:183], v[88:91]
    v_mfma_f32_16x16x32_bf16 v[92:95], v[168:171], v[160:163], v[92:95]
    v_mfma_f32_16x16x32_bf16 v[76:79], v[168:171], v[188:191], v[76:79]
    s_waitcnt vmcnt(0)
    v_mfma_f32_16x16x32_bf16 v[84:87], v[136:139], v[176:179], v[84:87]
    v_cmp_ne_u64 s[76:77], s[56:57], v[140:141]
    s_add_u32 s71, s72, 0
    v_mfma_f32_16x16x32_bf16 v[88:91], v[136:139], v[96:99], v[88:91]
    buffer_load_dwordx2 v[100:101], v110, s[40:43], s71 offen sc1
    s_add_u32 s71, s72, 65536
    v_mfma_f32_16x16x32_bf16 v[92:95], v[136:139], v[112:115], v[92:95]
    buffer_load_dwordx2 v[102:103], v110, s[40:43], s71 offen sc1
    s_add_u32 s71, s72, 131072
    v_mfma_f32_16x16x32_bf16 v[76:79], v[136:139], v[172:175], v[76:79]
    buffer_load_dwordx2 v[224:225], v110, s[40:43], s71 offen sc1
    s_add_u32 s71, s72, 196608
    buffer_load_dwordx2 v[226:227], v110, s[40:43], s71 offen sc1
    s_add_u32 s71, s72, s14
    buffer_load_dwordx2 v[108:109], v110, s[40:43], s71 offen sc1
    ds_write_b128 v252, v[84:87] offset:4096
    ds_write_b128 v252, v[88:91] offset:9216
    ds_write_b128 v252, v[92:95] offset:14336
    s_cmp_eq_u64 s[76:77], 0
    s_cbranch_scc1 L_z0_13
    buffer_load_dwordx2 v[140:141], v142, s[40:43], s70 offen sc1
L_z0_13:
    s_waitcnt lgkmcnt(0)
    s_mov_b64 exec, 1
    ds_add_u32 v1, v3 offset:16
    s_mov_b64 exec, -1
    s_mov_b32 s68, 0
L_lw_17:
    ds_read_b32 v251, v1 offset:16
    s_waitcnt lgkmcnt(0)
    v_readfirstlane_b32 s71, v251
    s_nop 0
    s_cmp_ge_u32 s71, 4
    s_cbranch_scc1 L_lwd_18
    s_add_u32 s68, s68, 1
    s_cmp_lt_u32 s68, 0x200000
    s_cbranch_scc1 L_lw_17
L_lwd_18:
    ds_read_b128 v[240:243], v248 offset:0
    ds_read_b128 v[116:119], v249 offset:5120
    ds_read_b128 v[132:135], v250 offset:10240
    ds_read_b128 v[244:247], v248 offset:1024
    ds_read_b128 v[144:147], v249 offset:6144
    ds_read_b128 v[192:195], v250 offset:11264
    ds_read_b128 v[164:167], v248 offset:2048
    ds_read_b128 v[236:239], v249 offset:7168
    ds_read_b128 v[232:235], v250 offset:12288
    ds_read_b128 v[228:231], v248 offset:3072
    ds_read_b128 v[204:207], v249 offset:8192
    ds_read_b128 v[200:203], v250 offset:13312
    ds_read_b128 v[196:199], v248 offset:4096
    ds_read_b128 v[124:127], v249 offset:9216
    ds_read_b128 v[168:171], v250 offset:14336
    s_cmp_eq_u64 s[76:77], 0
    s_cbranch_scc1 L_zok_15
    s_waitcnt vmcnt(0)
    v_cmp_ne_u64 vcc, s[56:57], v[140:141]
    s_cbranch_vccz L_z3_16
    s_mov_b32 s68, 0
L_pl_19:
    buffer_load_dwordx2 v[140:141], v142, s[40:43], s70 offen sc1
    s_waitcnt vmcnt(0)
    v_cmp_ne_u64_e64 vcc, s[56:57], v[140:141]
    s_nop 0
    s_and_b64 exec, exec, vcc
    s_cbranch_scc0 L_pld_20
    s_sleep 1
    s_add_u32 s68, s68, 1
    s_cmp_lt_u32 s68, 0x40000
    s_cbranch_scc1 L_pl_19
L_pld_20:
    s_mov_b64 exec, -1
L_z3_16:
    s_add_u32 s71, s72, 0
    buffer_load_dwordx2 v[100:101], v110, s[40:43], s71 offen sc1
    s_add_u32 s71, s72, 65536
    buffer_load_dwordx2 v[102:103], v110, s[40:43], s71 offen sc1
    s_add_u32 s71, s72, 131072
    buffer_load_dwordx2 v[224:225], v110, s[40:43], s71 offen sc1
    s_add_u32 s71, s72, 196608
    buffer_load_dwordx2 v[226:227], v110, s[40:43], s71 offen sc1
    s_add_u32 s71, s72, s14
    buffer_load_dwordx2 v[108:109], v110, s[40:43], s71 offen sc1
    s_waitcnt vmcnt(0)
L_zok_15:
    s_waitcnt vmcnt(0)
    v_lshlrev_b32 v216, 16, v158
    v_lshlrev_b32 v212, 16, v148
    v_and_b32 v213, s67, v148
    v_lshlrev_b32 v214, 16, v149
    v_and_b32 v215, s67, v149
    v_lshlrev_b32 v220, 16, v100
    v_and_b32 v221, s67, v100
    v_lshlrev_b32 v222, 16, v101
    v_and_b32_e64 v223, s67, v101
    v_pk_add_f32 v[212:213], v[212:213], v[220:221]
    v_pk_add_f32 v[214:215], v[214:215], v[222:223]
    v_cvt_pk_bf16_f32 v220, v212, v213
    v_cvt_pk_bf16_f32 v222, v214, v215
    v_lshlrev_b32 v212, 16, v220
    v_and_b32 v213, s67, v220
    v_lshlrev_b32 v214, 16, v222
    v_and_b32 v215, s67, v222
    v_lshlrev_b32 v104, 16, v150
    v_and_b32 v105, s67, v150
    v_lshlrev_b32 v106, 16, v151
    v_and_b32 v107, s67, v151
    v_lshlrev_b32 v220, 16, v102
    v_and_b32 v221, s67, v102
    v_lshlrev_b32 v222, 16, v103
    v_and_b32 v223, s67, v103
    v_pk_add_f32 v[104:105], v[104:105], v[220:221]
    v_pk_add_f32 v[106:107], v[106:107], v[222:223]
    v_cvt_pk_bf16_f32 v220, v104, v105
    v_cvt_pk_bf16_f32 v222, v106, v107
    v_lshlrev_b32 v104, 16, v220
    v_and_b32 v105, s67, v220
    v_lshlrev_b32 v106, 16, v222
    v_and_b32 v107, s67, v222
    v_lshlrev_b32 v120, 16, v152
    v_and_b32 v121, s67, v152
    v_lshlrev_b32 v122, 16, v153
    v_and_b32 v123, s67, v153
    v_lshlrev_b32 v220, 16, v224
    v_and_b32 v221, s67, v224
    v_lshlrev_b32 v222, 16, v225
    v_and_b32 v223, s67, v225
    v_pk_add_f32 v[120:121], v[120:121], v[220:221]
    v_pk_add_f32 v[122:123], v[122:123], v[222:223]
    v_cvt_pk_bf16_f32 v220, v120, v121
    v_cvt_pk_bf16_f32 v222, v122, v123
    v_lshlrev_b32 v120, 16, v220
    v_and_b32 v121, s67, v220
    v_lshlrev_b32 v122, 16, v222
    v_and_b32 v123, s67, v222
    v_lshlrev_b32 v208, 16, v154
    v_and_b32 v209, s67, v154
    v_lshlrev_b32 v210, 16, v155
    v_and_b32 v211, s67, v155
    v_lshlrev_b32 v220, 16, v226
    v_and_b32 v221, s67, v226
    v_lshlrev_b32 v222, 16, v227
    v_and_b32 v223, s67, v227
    v_pk_add_f32 v[208:209], v[208:209], v[220:221]
    v_pk_add_f32 v[210:211], v[210:211], v[222:223]
    v_cvt_pk_bf16_f32 v220, v208, v209
    v_cvt_pk_bf16_f32 v222, v210, v211
    v_lshlrev_b32 v208, 16, v220
    v_and_b32 v209, s67, v220
    v_lshlrev_b32 v210, 16, v222
    v_and_b32 v211, s67, v222
    v_lshlrev_b32 v128, 16, v156
    v_and_b32 v129, s67, v156
    v_lshlrev_b32 v130, 16, v157
    v_and_b32 v131, s67, v157
    v_lshlrev_b32 v220, 16, v108
    v_and_b32 v221, s67, v108
    v_lshlrev_b32 v222, 16, v109
    v_and_b32 v223, s67, v109
    v_pk_add_f32 v[128:129], v[128:129], v[220:221]
    v_pk_add_f32 v[130:131], v[130:131], v[222:223]
    v_cvt_pk_bf16_f32 v220, v128, v129
    v_cvt_pk_bf16_f32 v222, v130, v131
    v_lshlrev_b32 v128, 16, v220
    v_and_b32 v129, s67, v220
    v_lshlrev_b32 v130, 16, v222
    v_and_b32_e64 v131, s67, v222
    s_waitcnt lgkmcnt(12)
    v_pk_add_f32 v[12:13], v[12:13], v[240:241]
    v_pk_add_f32 v[116:117], v[116:117], v[132:133]
    v_pk_add_f32 v[14:15], v[14:15], v[242:243]
    v_pk_add_f32 v[118:119], v[118:119], v[134:135]
    v_pk_add_f32 v[12:13], v[12:13], v[116:117]
    v_pk_add_f32 v[14:15], v[14:15], v[118:119]
    v_cvt_pk_bf16_f32 v220, v12, v13
    v_cvt_pk_bf16_f32 v222, v14, v15
    v_lshlrev_b32 v12, 16, v220
    v_and_b32 v13, s67, v220
    v_lshlrev_b32 v14, 16, v222
    v_and_b32 v15, s67, v222
    v_pk_add_f32 v[12:13], v[12:13], v[216:217] op_sel_hi:[1,0]
    v_pk_add_f32 v[14:15], v[14:15], v[216:217] op_sel_hi:[1,0]
    v_cvt_pk_bf16_f32 v220, v12, v13
    v_cvt_pk_bf16_f32 v222, v14, v15
    v_lshlrev_b32 v12, 16, v220
    v_and_b32 v13, s67, v220
    v_lshlrev_b32 v14, 16, v222
    v_and_b32 v15, s67, v222
    v_pk_add_f32 v[12:13], v[12:13], v[212:213]
    v_pk_add_f32 v[14:15], v[14:15], v[214:215]
    v_cvt_pk_bf16_f32 v240, v12, v13
    v_cvt_pk_bf16_f32 v241, v14, v15
    s_waitcnt lgkmcnt(9)
    s_nop 0
    v_pk_add_f32 v[28:29], v[28:29], v[244:245]
    v_pk_add_f32 v[144:145], v[144:145], v[192:193]
    v_pk_add_f32 v[30:31], v[30:31], v[246:247]
    v_pk_add_f32 v[146:147], v[146:147], v[194:195]
    v_pk_add_f32 v[28:29], v[28:29], v[144:145]
    v_pk_add_f32 v[30:31], v[30:31], v[146:147]
    v_cvt_pk_bf16_f32 v220, v28, v29
    v_cvt_pk_bf16_f32 v222, v30, v31
    v_lshlrev_b32 v28, 16, v220
    v_and_b32 v29, s67, v220
    v_lshlrev_b32 v30, 16, v222
    v_and_b32 v31, s67, v222
    v_pk_add_f32 v[28:29], v[28:29], v[216:217] op_sel_hi:[1,0]
    v_pk_add_f32 v[30:31], v[30:31], v[216:217] op_sel_hi:[1,0]
    v_cvt_pk_bf16_f32 v220, v28, v29
    v_cvt_pk_bf16_f32 v222, v30, v31
    v_lshlrev_b32 v28, 16, v220
    v_and_b32 v29, s67, v220
    v_lshlrev_b32 v30, 16, v222
    v_and_b32 v31, s67, v222
    v_pk_add_f32 v[28:29], v[28:29], v[104:105]
    v_pk_add_f32 v[30:31], v[30:31], v[106:107]
    v_cvt_pk_bf16_f32 v242, v28, v29
    v_cvt_pk_bf16_f32 v243, v30, v31
    s_nop 0
    v_permlane16_swap_b32 v240, v242
    v_permlane16_swap_b32 v241, v243
    buffer_store_dwordx4 v[240:243], v80, s[52:55], 0 offen offset:0
    s_waitcnt lgkmcnt(6)
    v_pk_add_f32 v[44:45], v[44:45], v[164:165]
    v_pk_add_f32 v[236:237], v[236:237], v[232:233]
    v_pk_add_f32 v[46:47], v[46:47], v[166:167]
    v_pk_add_f32 v[238:239], v[238:239], v[234:235]
    v_pk_add_f32 v[44:45], v[44:45], v[236:237]
    v_pk_add_f32 v[46:47], v[46:47], v[238:239]
    v_cvt_pk_bf16_f32 v220, v44, v45
    v_cvt_pk_bf16_f32 v222, v46, v47
    v_lshlrev_b32 v44, 16, v220
    v_and_b32 v45, s67, v220
    v_lshlrev_b32 v46, 16, v222
    v_and_b32 v47, s67, v222
    v_pk_add_f32 v[44:45], v[44:45], v[216:217] op_sel_hi:[1,0]
    v_pk_add_f32 v[46:47], v[46:47], v[216:217] op_sel_hi:[1,0]
    v_cvt_pk_bf16_f32 v220, v44, v45
    v_cvt_pk_bf16_f32 v222, v46, v47
    v_lshlrev_b32 v44, 16, v220
    v_and_b32 v45, s67, v220
    v_lshlrev_b32 v46, 16, v222
    v_and_b32 v47, s67, v222
    v_pk_add_f32 v[44:45], v[44:45], v[120:121]
    v_pk_add_f32 v[46:47], v[46:47], v[122:123]
    v_cvt_pk_bf16_f32 v164, v44, v45
    v_cvt_pk_bf16_f32 v165, v46, v47
    s_waitcnt lgkmcnt(3)
    s_nop 0
    v_pk_add_f32 v[60:61], v[60:61], v[228:229]
    v_pk_add_f32 v[204:205], v[204:205], v[200:201]
    v_pk_add_f32 v[62:63], v[62:63], v[230:231]
    v_pk_add_f32 v[206:207], v[206:207], v[202:203]
    v_pk_add_f32 v[60:61], v[60:61], v[204:205]
    v_pk_add_f32 v[62:63], v[62:63], v[206:207]
    v_cvt_pk_bf16_f32 v220, v60, v61
    v_cvt_pk_bf16_f32 v222, v62, v63
    v_lshlrev_b32 v60, 16, v220
    v_and_b32 v61, s67, v220
    v_lshlrev_b32 v62, 16, v222
    v_and_b32 v63, s67, v222
    v_pk_add_f32 v[60:61], v[60:61], v[216:217] op_sel_hi:[1,0]
    v_pk_add_f32 v[62:63], v[62:63], v[216:217] op_sel_hi:[1,0]
    v_cvt_pk_bf16_f32 v220, v60, v61
    v_cvt_pk_bf16_f32 v222, v62, v63
    v_lshlrev_b32 v60, 16, v220
    v_and_b32 v61, s67, v220
    v_lshlrev_b32 v62, 16, v222
    v_and_b32 v63, s67, v222
    v_pk_add_f32 v[60:61], v[60:61], v[208:209]
    v_pk_add_f32 v[62:63], v[62:63], v[210:211]
    v_cvt_pk_bf16_f32 v166, v60, v61
    v_cvt_pk_bf16_f32 v167, v62, v63
    s_nop 0
    v_permlane16_swap_b32 v164, v166
    v_permlane16_swap_b32 v165, v167
    buffer_store_dwordx4 v[164:167], v80, s[52:55], 0 offen offset:64
    s_waitcnt lgkmcnt(0)
    v_pk_add_f32 v[76:77], v[76:77], v[196:197]
    v_pk_add_f32 v[124:125], v[124:125], v[168:169]
    v_pk_add_f32 v[78:79], v[78:79], v[198:199]
    v_pk_add_f32 v[126:127], v[126:127], v[170:171]
    v_pk_add_f32 v[76:77], v[76:77], v[124:125]
    v_pk_add_f32 v[78:79], v[78:79], v[126:127]
    v_cvt_pk_bf16_f32 v220, v76, v77
    v_cvt_pk_bf16_f32 v222, v78, v79
    v_lshlrev_b32 v76, 16, v220
    v_and_b32 v77, s67, v220
    v_lshlrev_b32 v78, 16, v222
    v_and_b32 v79, s67, v222
    v_pk_add_f32 v[76:77], v[76:77], v[216:217] op_sel_hi:[1,0]
    v_pk_add_f32 v[78:79], v[78:79], v[216:217] op_sel_hi:[1,0]
    v_cvt_pk_bf16_f32 v220, v76, v77
    v_cvt_pk_bf16_f32 v222, v78, v79
    v_lshlrev_b32 v76, 16, v220
    v_and_b32 v77, s67, v220
    v_lshlrev_b32 v78, 16, v222
    v_and_b32 v79, s67, v222
    v_pk_add_f32 v[76:77], v[76:77], v[128:129]
    v_pk_add_f32 v[78:79], v[78:79], v[130:131]
    v_cvt_pk_bf16_f32 v196, v76, v77
    v_cvt_pk_bf16_f32 v197, v78, v79
    buffer_store_dwordx2 v[196:197], v159, s[52:55], 0 offen offset:0
    s_or_b32 s70, s2, s58
    s_cmp_lg_u32 s70, 0
    s_cbranch_scc1 L_nb_21
    v_mov_b32 v220, s56
    v_mov_b32 v221, s57
    s_mov_b64 exec, 1
    global_store_dwordx2 v1, v[220:221], s[32:33]
    s_mov_b64 exec, -1
L_nb_21:
    s_endpgm
L_S:
    s_setprio 3
    ds_read_b64_tr_b16 v[140:141], v16 offset:10752
    ds_read_b64_tr_b16 v[142:143], v16 offset:16128
    ds_read_b64_tr_b16 v[144:145], v16 offset:11264
    ds_read_b64_tr_b16 v[146:147], v16 offset:16640
    ds_read_b64_tr_b16 v[148:149], v16 offset:11776
    ds_read_b64_tr_b16 v[150:151], v16 offset:17152
    ds_read_b64_tr_b16 v[36:37], v16 offset:0
    ds_read_b64_tr_b16 v[38:39], v16 offset:5376
    ds_read_b64_tr_b16 v[40:41], v16 offset:512
    ds_read_b64_tr_b16 v[42:43], v16 offset:5888
    ds_read_b64_tr_b16 v[44:45], v16 offset:1024
    ds_read_b64_tr_b16 v[46:47], v16 offset:6400
    v_mov_b32 v48, v18
    s_mov_b32 s72, s69
    s_waitcnt lgkmcnt(10)
    buffer_store_dwordx4 v[140:143], v17, s[40:43], s75 offen sc1
    s_add_u32 s70, s75, 0x100000
    s_waitcnt lgkmcnt(8)
    buffer_store_dwordx4 v[144:147], v17, s[40:43], s70 offen sc1
    s_add_u32 s70, s75, s3
    s_waitcnt lgkmcnt(6)
    buffer_store_dwordx4 v[148:151], v17, s[40:43], s70 offen sc1
    s_waitcnt lgkmcnt(0)
    v_mov_b32 v9, 0
    v_mov_b32_e64 v10, 1
    s_mov_b64 exec, 1
    ds_add_u32 v9, v10 offset:0
    s_mov_b64 exec, -1
    s_cmp_lg_u32 s64, 0
    s_cbranch_scc1 L_S_go
    s_waitcnt vmcnt(0)
    s_call_b64 s[74:75], L_send1
    s_setprio 3
    s_waitcnt vmcnt(0)
    s_call_b64 s[74:75], L_send1
    s_branch L_S_exit
L_S_go:
    s_setprio 0
    s_mov_b32 m0, s78
    s_waitcnt vmcnt(3)
    v_mov_b32 v1, 0x3fb8aa3b
    v_lshlrev_b32 v2, 16, v250
    v_mul_f32 v2, v1, v2
    v_exp_f32 v2, v2
    v_lshlrev_b32 v4, 16, v251
    v_cvt_pk_bf16_f32 v2, v2, v2
    v_and_b32 v2, s67, v2
    s_mov_b32 s73, 0
    v_lshlrev_b32 v5, 16, v238
    v_lshlrev_b32 v6, 16, v239
    v_lshlrev_b32 v7, 16, v240
    v_lshlrev_b32 v8, 16, v241
    v_mul_f32 v20, v1, v5
    v_exp_f32 v20, v20
    v_mul_f32 v21, v6, v2
    v_mul_f32 v21, 0.15915494, v21
    v_cvt_pk_bf16_f32 v20, v20, v20
    v_and_b32 v20, s67, v20
    v_mul_f32 v20, v20, v2
    v_mul_f32 v20, v20, v1
    v_add_f32 v5, v2, v2
    v_mul_f32_e64 v22, v7, v5
    v_mul_f32 v23, -v8, v5
    v_mul_f32 v5, 0xbf800000, v20
    v_mul_f32 v6, 0x3f800000, v21
    v_exp_f32 v5, v5
    v_fract_f32 v6, v6
    v_cos_f32 v7, v6
    v_sin_f32 v8, v6
    v_mul_f32 v10, v5, v7
    v_mul_f32 v11, v5, v8
    v_mul_f32 v5, 0xc1000000, v20
    v_mul_f32 v6, 0x41000000, v21
    v_exp_f32 v5, v5
    v_fract_f32 v6, v6
    v_cos_f32 v7, v6
    v_sin_f32 v8, v6
    v_mul_f32 v16, v5, v7
    v_mul_f32 v17, v5, v8
    v_mul_f32 v5, 0xc3000000, v20
    v_mul_f32 v6, 0x43000000, v21
    v_exp_f32 v5, v5
    v_fract_f32 v6, v6
    v_cos_f32 v7, v6
    v_sin_f32 v8, v6
    v_mul_f32 v18, v5, v7
    v_mul_f32 v19, v5, v8
    s_getreg_b32 s71, hwreg(HW_REG_IB_STS, 0, 4)
    s_or_b32 s71, s71, s73
    s_cbranch_scc1 L_nf_22
    s_call_b64 s[74:75], L_send1
L_nf_22:
    v_pk_mul_f32 v[30:31], v[10:11], v[10:11] op_sel:[0,0] op_sel_hi:[0,1]
    v_pk_fma_f32 v[12:13], v[10:11], v[10:11], v[30:31] op_sel:[1,1,0] op_sel_hi:[1,0,1] neg_lo:[0,1,0]
    v_pk_mul_f32 v[30:31], v[12:13], v[12:13] op_sel:[0,0] op_sel_hi:[0,1]
    v_pk_fma_f32 v[14:15], v[12:13], v[12:13], v[30:31] op_sel:[1,1,0] op_sel_hi:[1,0,1] neg_lo:[0,1,0]
    v_mov_b32 v76, 0x3f80
    v_pk_mul_f32 v[30:31], v[16:17], v[16:17] op_sel:[0,0] op_sel_hi:[0,1]
    v_cvt_pk_bf16_f32 v77, v16, v17
    v_pk_fma_f32 v[26:27], v[16:17], v[16:17], v[30:31] op_sel:[1,1,0] op_sel_hi:[1,0,1] neg_lo:[0,1,0]
    v_pk_mul_f32 v[30:31], v[26:27], v[16:17] op_sel:[0,0] op_sel_hi:[0,1]
    v_cvt_pk_bf16_f32 v78, v26, v27
    v_pk_fma_f32 v[28:29], v[26:27], v[16:17], v[30:31] op_sel:[1,1,0] op_sel_hi:[1,0,1] neg_lo:[0,1,0]
    v_pk_mul_f32 v[30:31], v[28:29], v[16:17] op_sel:[0,0] op_sel_hi:[0,1]
    v_cvt_pk_bf16_f32 v79, v28, v29
    v_pk_fma_f32 v[26:27], v[28:29], v[16:17], v[30:31] op_sel:[1,1,0] op_sel_hi:[1,0,1] neg_lo:[0,1,0]
    v_pk_mul_f32 v[30:31], v[26:27], v[16:17] op_sel:[0,0] op_sel_hi:[0,1]
    v_cvt_pk_bf16_f32 v80, v26, v27
    v_pk_fma_f32 v[28:29], v[26:27], v[16:17], v[30:31] op_sel:[1,1,0] op_sel_hi:[1,0,1] neg_lo:[0,1,0]
    v_pk_mul_f32 v[30:31], v[28:29], v[16:17] op_sel:[0,0] op_sel_hi:[0,1]
    v_cvt_pk_bf16_f32 v81, v28, v29
    v_pk_fma_f32 v[26:27], v[28:29], v[16:17], v[30:31] op_sel:[1,1,0] op_sel_hi:[1,0,1] neg_lo:[0,1,0]
    v_pk_mul_f32 v[30:31], v[26:27], v[16:17] op_sel:[0,0] op_sel_hi:[0,1]
    v_cvt_pk_bf16_f32 v82, v26, v27
    v_pk_fma_f32 v[28:29], v[26:27], v[16:17], v[30:31] op_sel:[1,1,0] op_sel_hi:[1,0,1] neg_lo:[0,1,0]
    v_pk_mul_f32 v[30:31], v[28:29], v[16:17] op_sel:[0,0] op_sel_hi:[0,1]
    v_cvt_pk_bf16_f32 v83, v28, v29
    v_pk_fma_f32 v[26:27], v[28:29], v[16:17], v[30:31] op_sel:[1,1,0] op_sel_hi:[1,0,1] neg_lo:[0,1,0]
    s_getreg_b32 s71, hwreg(HW_REG_IB_STS, 0, 4)
    s_or_b32 s71, s71, s73
    s_cbranch_scc1 L_nf_23
    s_call_b64 s[74:75], L_send1
L_nf_23:
    v_pk_mul_f32 v[30:31], v[26:27], v[16:17] op_sel:[0,0] op_sel_hi:[0,1]
    v_cvt_pk_bf16_f32 v84, v26, v27
    v_pk_fma_f32 v[28:29], v[26:27], v[16:17], v[30:31] op_sel:[1,1,0] op_sel_hi:[1,0,1] neg_lo:[0,1,0]
    v_pk_mul_f32 v[30:31], v[28:29], v[16:17] op_sel:[0,0] op_sel_hi:[0,1]
    v_cvt_pk_bf16_f32 v85, v28, v29
    v_pk_fma_f32 v[26:27], v[28:29], v[16:17], v[30:31] op_sel:[1,1,0] op_sel_hi:[1,0,1] neg_lo:[0,1,0]
    v_pk_mul_f32 v[30:31], v[26:27], v[16:17] op_sel:[0,0] op_sel_hi:[0,1]
    v_cvt_pk_bf16_f32 v86, v26, v27
    v_pk_fma_f32 v[28:29], v[26:27], v[16:17], v[30:31] op_sel:[1,1,0] op_sel_hi:[1,0,1] neg_lo:[0,1,0]
    v_pk_mul_f32 v[30:31], v[28:29], v[16:17] op_sel:[0,0] op_sel_hi:[0,1]
    v_cvt_pk_bf16_f32 v87, v28, v29
    v_pk_fma_f32 v[26:27], v[28:29], v[16:17], v[30:31] op_sel:[1,1,0] op_sel_hi:[1,0,1] neg_lo:[0,1,0]
    v_pk_mul_f32 v[30:31], v[26:27], v[16:17] op_sel:[0,0] op_sel_hi:[0,1]
    v_cvt_pk_bf16_f32 v88, v26, v27
    v_pk_fma_f32 v[28:29], v[26:27], v[16:17], v[30:31] op_sel:[1,1,0] op_sel_hi:[1,0,1] neg_lo:[0,1,0]
    v_pk_mul_f32 v[30:31], v[28:29], v[16:17] op_sel:[0,0] op_sel_hi:[0,1]
    v_cvt_pk_bf16_f32 v89, v28, v29
    v_pk_fma_f32 v[26:27], v[28:29], v[16:17], v[30:31] op_sel:[1,1,0] op_sel_hi:[1,0,1] neg_lo:[0,1,0]
    v_pk_mul_f32 v[30:31], v[26:27], v[16:17] op_sel:[0,0] op_sel_hi:[0,1]
    v_cvt_pk_bf16_f32 v90, v26, v27
    v_pk_fma_f32 v[28:29], v[26:27], v[16:17], v[30:31] op_sel:[1,1,0] op_sel_hi:[1,0,1] neg_lo:[0,1,0]
    v_cvt_pk_bf16_f32 v91, v28, v29
    v_pk_mul_f32 v[30:31], v[22:23], v[10:11] op_sel:[0,0] op_sel_hi:[0,1] neg_hi:[0,1]
    v_cvt_pk_bf16_f32 v92, v22, v23
    v_pk_fma_f32 v[28:29], v[22:23], v[10:11], v[30:31] op_sel:[1,1,0] op_sel_hi:[1,0,1]
    v_pk_mul_f32 v[30:31], v[28:29], v[10:11] op_sel:[0,0] op_sel_hi:[0,1] neg_hi:[0,1]
    v_cvt_pk_bf16_f32 v93, v28, v29
    v_pk_fma_f32 v[26:27], v[28:29], v[10:11], v[30:31] op_sel:[1,1,0] op_sel_hi:[1,0,1]
    s_getreg_b32 s71, hwreg(HW_REG_IB_STS, 0, 4)
    s_or_b32 s71, s71, s73
    s_cbranch_scc1 L_nf_24
    s_call_b64 s[74:75], L_send1
L_nf_24:
    v_pk_mul_f32 v[30:31], v[26:27], v[10:11] op_sel:[0,0] op_sel_hi:[0,1] neg_hi:[0,1]
    v_cvt_pk_bf16_f32 v94, v26, v27
    v_pk_fma_f32 v[28:29], v[26:27], v[10:11], v[30:31] op_sel:[1,1,0] op_sel_hi:[1,0,1]
    v_pk_mul_f32 v[30:31], v[28:29], v[10:11] op_sel:[0,0] op_sel_hi:[0,1] neg_hi:[0,1]
    v_cvt_pk_bf16_f32 v95, v28, v29
    v_pk_fma_f32 v[26:27], v[28:29], v[10:11], v[30:31] op_sel:[1,1,0] op_sel_hi:[1,0,1]
    v_pk_mul_f32 v[30:31], v[26:27], v[10:11] op_sel:[0,0] op_sel_hi:[0,1] neg_hi:[0,1]
    v_cvt_pk_bf16_f32 v96, v26, v27
    v_pk_fma_f32 v[28:29], v[26:27], v[10:11], v[30:31] op_sel:[1,1,0] op_sel_hi:[1,0,1]
    v_pk_mul_f32 v[30:31], v[28:29], v[10:11] op_sel:[0,0] op_sel_hi:[0,1] neg_hi:[0,1]
    v_cvt_pk_bf16_f32 v97, v28, v29
    v_pk_fma_f32 v[26:27], v[28:29], v[10:11], v[30:31] op_sel:[1,1,0] op_sel_hi:[1,0,1]
    v_pk_mul_f32 v[30:31], v[26:27], v[10:11] op_sel:[0,0] op_sel_hi:[0,1] neg_hi:[0,1]
    v_cvt_pk_bf16_f32 v98, v26, v27
    v_pk_fma_f32 v[28:29], v[26:27], v[10:11], v[30:31] op_sel:[1,1,0] op_sel_hi:[1,0,1]
    v_pk_mul_f32 v[30:31], v[22:23], v[18:19] op_sel:[0,0] op_sel_hi:[0,1] neg_hi:[0,1]
    v_cvt_pk_bf16_f32 v99, v28, v29
    v_pk_fma_f32 v[24:25], v[22:23], v[18:19], v[30:31] op_sel:[1,1,0] op_sel_hi:[1,0,1]
    v_pk_mul_f32 v[30:31], v[24:25], v[10:11] op_sel:[0,0] op_sel_hi:[0,1] neg_hi:[0,1]
    v_cvt_pk_bf16_f32 v100, v24, v25
    v_pk_fma_f32 v[28:29], v[24:25], v[10:11], v[30:31] op_sel:[1,1,0] op_sel_hi:[1,0,1]
    v_pk_mul_f32 v[30:31], v[28:29], v[10:11] op_sel:[0,0] op_sel_hi:[0,1] neg_hi:[0,1]
    v_cvt_pk_bf16_f32 v101, v28, v29
    v_pk_fma_f32 v[26:27], v[28:29], v[10:11], v[30:31] op_sel:[1,1,0] op_sel_hi:[1,0,1]
    v_pk_mul_f32 v[30:31], v[26:27], v[10:11] op_sel:[0,0] op_sel_hi:[0,1] neg_hi:[0,1]
    v_cvt_pk_bf16_f32 v102, v26, v27
    v_pk_fma_f32 v[28:29], v[26:27], v[10:11], v[30:31] op_sel:[1,1,0] op_sel_hi:[1,0,1]
    s_getreg_b32 s71, hwreg(HW_REG_IB_STS, 0, 4)
    s_or_b32 s71, s71, s73
    s_cbranch_scc1 L_nf_25
    s_call_b64 s[74:75], L_send1
L_nf_25:
    v_pk_mul_f32 v[30:31], v[28:29], v[10:11] op_sel:[0,0] op_sel_hi:[0,1] neg_hi:[0,1]
    v_cvt_pk_bf16_f32 v103, v28, v29
    v_pk_fma_f32 v[26:27], v[28:29], v[10:11], v[30:31] op_sel:[1,1,0] op_sel_hi:[1,0,1]
    v_pk_mul_f32 v[30:31], v[26:27], v[10:11] op_sel:[0,0] op_sel_hi:[0,1] neg_hi:[0,1]
    v_cvt_pk_bf16_f32 v104, v26, v27
    v_pk_fma_f32 v[28:29], v[26:27], v[10:11], v[30:31] op_sel:[1,1,0] op_sel_hi:[1,0,1]
    v_pk_mul_f32 v[30:31], v[28:29], v[10:11] op_sel:[0,0] op_sel_hi:[0,1] neg_hi:[0,1]
    v_cvt_pk_bf16_f32 v105, v28, v29
    v_pk_fma_f32 v[26:27], v[28:29], v[10:11], v[30:31] op_sel:[1,1,0] op_sel_hi:[1,0,1]
    v_pk_mul_f32 v[30:31], v[26:27], v[10:11] op_sel:[0,0] op_sel_hi:[0,1] neg_hi:[0,1]
    v_cvt_pk_bf16_f32 v106, v26, v27
    v_pk_fma_f32 v[28:29], v[26:27], v[10:11], v[30:31] op_sel:[1,1,0] op_sel_hi:[1,0,1]
    v_pk_mul_f32 v[30:31], v[24:25], v[18:19] op_sel:[0,0] op_sel_hi:[0,1] neg_hi:[0,1]
    v_cvt_pk_bf16_f32 v107, v28, v29
    v_pk_fma_f32 v[22:23], v[24:25], v[18:19], v[30:31] op_sel:[1,1,0] op_sel_hi:[1,0,1]
    v_pk_mul_f32 v[30:31], v[22:23], v[12:13] op_sel:[0,0] op_sel_hi:[0,1] neg_hi:[0,1]
    v_cvt_pk_bf16_f32 v108, v22, v23
    v_pk_fma_f32 v[28:29], v[22:23], v[12:13], v[30:31] op_sel:[1,1,0] op_sel_hi:[1,0,1]
    v_pk_mul_f32 v[30:31], v[28:29], v[12:13] op_sel:[0,0] op_sel_hi:[0,1] neg_hi:[0,1]
    v_cvt_pk_bf16_f32 v109, v28, v29
    v_pk_fma_f32 v[26:27], v[28:29], v[12:13], v[30:31] op_sel:[1,1,0] op_sel_hi:[1,0,1]
    v_pk_mul_f32 v[30:31], v[26:27], v[12:13] op_sel:[0,0] op_sel_hi:[0,1] neg_hi:[0,1]
    v_cvt_pk_bf16_f32 v110, v26, v27
    v_pk_fma_f32 v[28:29], v[26:27], v[12:13], v[30:31] op_sel:[1,1,0] op_sel_hi:[1,0,1]
    v_pk_mul_f32 v[30:31], v[22:23], v[18:19] op_sel:[0,0] op_sel_hi:[0,1] neg_hi:[0,1]
    v_cvt_pk_bf16_f32 v111, v28, v29
    v_pk_fma_f32 v[24:25], v[22:23], v[18:19], v[30:31] op_sel:[1,1,0] op_sel_hi:[1,0,1]
    s_getreg_b32 s71, hwreg(HW_REG_IB_STS, 0, 4)
    s_or_b32 s71, s71, s73
    s_cbranch_scc1 L_nf_26
    s_call_b64 s[74:75], L_send1
L_nf_26:
    v_pk_mul_f32 v[30:31], v[24:25], v[12:13] op_sel:[0,0] op_sel_hi:[0,1] neg_hi:[0,1]
    v_cvt_pk_bf16_f32 v112, v24, v25
    v_pk_fma_f32 v[28:29], v[24:25], v[12:13], v[30:31] op_sel:[1,1,0] op_sel_hi:[1,0,1]
    v_pk_mul_f32 v[30:31], v[28:29], v[12:13] op_sel:[0,0] op_sel_hi:[0,1] neg_hi:[0,1]
    v_cvt_pk_bf16_f32 v113, v28, v29
    v_pk_fma_f32 v[26:27], v[28:29], v[12:13], v[30:31] op_sel:[1,1,0] op_sel_hi:[1,0,1]
    v_pk_mul_f32 v[30:31], v[26:27], v[12:13] op_sel:[0,0] op_sel_hi:[0,1] neg_hi:[0,1]
    v_cvt_pk_bf16_f32 v114, v26, v27
    v_pk_fma_f32 v[28:29], v[26:27], v[12:13], v[30:31] op_sel:[1,1,0] op_sel_hi:[1,0,1]
    v_pk_mul_f32 v[30:31], v[24:25], v[18:19] op_sel:[0,0] op_sel_hi:[0,1] neg_hi:[0,1]
    v_cvt_pk_bf16_f32 v115, v28, v29
    v_pk_fma_f32 v[22:23], v[24:25], v[18:19], v[30:31] op_sel:[1,1,0] op_sel_hi:[1,0,1]
    v_pk_mul_f32 v[30:31], v[22:23], v[14:15] op_sel:[0,0] op_sel_hi:[0,1] neg_hi:[0,1]
    v_cvt_pk_bf16_f32 v116, v22, v23
    v_pk_fma_f32 v[28:29], v[22:23], v[14:15], v[30:31] op_sel:[1,1,0] op_sel_hi:[1,0,1]
    v_pk_mul_f32 v[30:31], v[22:23], v[18:19] op_sel:[0,0] op_sel_hi:[0,1] neg_hi:[0,1]
    v_cvt_pk_bf16_f32 v117, v28, v29
    v_pk_fma_f32 v[24:25], v[22:23], v[18:19], v[30:31] op_sel:[1,1,0] op_sel_hi:[1,0,1]
    v_pk_mul_f32 v[30:31], v[24:25], v[14:15] op_sel:[0,0] op_sel_hi:[0,1] neg_hi:[0,1]
    v_cvt_pk_bf16_f32 v118, v24, v25
    v_pk_fma_f32 v[28:29], v[24:25], v[14:15], v[30:31] op_sel:[1,1,0] op_sel_hi:[1,0,1]
    s_getreg_b32 s71, hwreg(HW_REG_IB_STS, 0, 4)
    s_or_b32 s71, s71, s73
    s_cbranch_scc1 L_nf_27
    s_call_b64 s[74:75], L_send1
L_nf_27:
    v_pk_mul_f32 v[30:31], v[24:25], v[18:19] op_sel:[0,0] op_sel_hi:[0,1] neg_hi:[0,1]
    v_cvt_pk_bf16_f32 v119, v28, v29
    v_pk_fma_f32 v[22:23], v[24:25], v[18:19], v[30:31] op_sel:[1,1,0] op_sel_hi:[1,0,1]
    v_pk_mul_f32 v[30:31], v[22:23], v[14:15] op_sel:[0,0] op_sel_hi:[0,1] neg_hi:[0,1]
    v_cvt_pk_bf16_f32 v120, v22, v23
    v_pk_fma_f32 v[28:29], v[22:23], v[14:15], v[30:31] op_sel:[1,1,0] op_sel_hi:[1,0,1]
    v_pk_mul_f32 v[30:31], v[22:23], v[18:19] op_sel:[0,0] op_sel_hi:[0,1] neg_hi:[0,1]
    v_cvt_pk_bf16_f32 v121, v28, v29
    v_pk_fma_f32 v[24:25], v[22:23], v[18:19], v[30:31] op_sel:[1,1,0] op_sel_hi:[1,0,1]
    v_pk_mul_f32 v[30:31], v[24:25], v[14:15] op_sel:[0,0] op_sel_hi:[0,1] neg_hi:[0,1]
    v_cvt_pk_bf16_f32 v122, v24, v25
    v_pk_fma_f32 v[28:29], v[24:25], v[14:15], v[30:31] op_sel:[1,1,0] op_sel_hi:[1,0,1]
    v_pk_mul_f32 v[30:31], v[24:25], v[18:19] op_sel:[0,0] op_sel_hi:[0,1] neg_hi:[0,1]
    v_cvt_pk_bf16_f32 v123, v28, v29
    v_pk_fma_f32 v[22:23], v[24:25], v[18:19], v[30:31] op_sel:[1,1,0] op_sel_hi:[1,0,1]
    v_pk_mul_f32 v[30:31], v[22:23], v[18:19] op_sel:[0,0] op_sel_hi:[0,1] neg_hi:[0,1]
    v_cvt_pk_bf16_f32 v124, v22, v23
    v_pk_fma_f32 v[24:25], v[22:23], v[18:19], v[30:31] op_sel:[1,1,0] op_sel_hi:[1,0,1]
    s_getreg_b32 s71, hwreg(HW_REG_IB_STS, 0, 4)
    s_or_b32 s71, s71, s73
    s_cbranch_scc1 L_nf_28
    s_call_b64 s[74:75], L_send1
L_nf_28:
    v_pk_mul_f32 v[30:31], v[24:25], v[18:19] op_sel:[0,0] op_sel_hi:[0,1] neg_hi:[0,1]
    v_cvt_pk_bf16_f32 v125, v24, v25
    v_pk_fma_f32 v[22:23], v[24:25], v[18:19], v[30:31] op_sel:[1,1,0] op_sel_hi:[1,0,1]
    v_pk_mul_f32 v[30:31], v[22:23], v[18:19] op_sel:[0,0] op_sel_hi:[0,1] neg_hi:[0,1]
    v_cvt_pk_bf16_f32 v126, v22, v23
    v_pk_fma_f32 v[24:25], v[22:23], v[18:19], v[30:31] op_sel:[1,1,0] op_sel_hi:[1,0,1]
    v_pk_mul_f32 v[30:31], v[24:25], v[18:19] op_sel:[0,0] op_sel_hi:[0,1] neg_hi:[0,1]
    v_cvt_pk_bf16_f32 v127, v24, v25
    v_pk_fma_f32 v[22:23], v[24:25], v[18:19], v[30:31] op_sel:[1,1,0] op_sel_hi:[1,0,1]
    v_pk_mul_f32 v[30:31], v[22:23], v[18:19] op_sel:[0,0] op_sel_hi:[0,1] neg_hi:[0,1]
    v_cvt_pk_bf16_f32 v128, v22, v23
    v_pk_fma_f32 v[24:25], v[22:23], v[18:19], v[30:31] op_sel:[1,1,0] op_sel_hi:[1,0,1]
    v_pk_mul_f32 v[30:31], v[24:25], v[18:19] op_sel:[0,0] op_sel_hi:[0,1] neg_hi:[0,1]
    v_cvt_pk_bf16_f32 v129, v24, v25
    v_pk_fma_f32 v[22:23], v[24:25], v[18:19], v[30:31] op_sel:[1,1,0] op_sel_hi:[1,0,1]
    s_getreg_b32 s71, hwreg(HW_REG_IB_STS, 0, 4)
    s_or_b32 s71, s71, s73
    s_cbranch_scc1 L_nf_29
    s_call_b64 s[74:75], L_send1
L_nf_29:
    v_pk_mul_f32 v[30:31], v[22:23], v[18:19] op_sel:[0,0] op_sel_hi:[0,1] neg_hi:[0,1]
    v_cvt_pk_bf16_f32 v130, v22, v23
    v_pk_fma_f32 v[24:25], v[22:23], v[18:19], v[30:31] op_sel:[1,1,0] op_sel_hi:[1,0,1]
    v_pk_mul_f32 v[30:31], v[24:25], v[18:19] op_sel:[0,0] op_sel_hi:[0,1] neg_hi:[0,1]
    v_cvt_pk_bf16_f32 v131, v24, v25
    v_pk_fma_f32 v[22:23], v[24:25], v[18:19], v[30:31] op_sel:[1,1,0] op_sel_hi:[1,0,1]
    v_cvt_pk_bf16_f32 v132, v22, v23
    v_and_b32 v5, s67, v238
    v_and_b32 v6, s67, v239
    v_and_b32 v7, s67, v240
    v_and_b32 v8, s67, v241
    v_mul_f32 v20, v1, v5
    v_exp_f32 v20, v20
    v_mul_f32 v21, v6, v2
    v_mul_f32 v21, 0.15915494, v21
    v_cvt_pk_bf16_f32 v20, v20, v20
    v_and_b32 v20, s67, v20
    v_mul_f32 v20, v20, v2
    v_mul_f32 v20, v20, v1
    v_add_f32 v5, v2, v2
    v_mul_f32_e64 v22, v7, v5
    v_mul_f32 v23, -v8, v5
    v_mul_f32 v5, 0xbf800000, v20
    v_mul_f32 v6, 0x3f800000, v21
    v_exp_f32 v5, v5
    v_fract_f32 v6, v6
    v_cos_f32 v7, v6
    v_sin_f32 v8, v6
    v_mul_f32 v10, v5, v7
    v_mul_f32 v11, v5, v8
    v_mul_f32 v5, 0xc1000000, v20
    v_mul_f32 v6, 0x41000000, v21
    v_exp_f32 v5, v5
    v_fract_f32 v6, v6
    v_cos_f32 v7, v6
    v_sin_f32 v8, v6
    v_mul_f32 v16, v5, v7
    v_mul_f32 v17, v5, v8
    v_mul_f32 v5, 0xc3000000, v20
    v_mul_f32 v6, 0x43000000, v21
    v_exp_f32 v5, v5
    v_fract_f32 v6, v6
    v_cos_f32 v7, v6
    v_sin_f32 v8, v6
    v_mul_f32 v18, v5, v7
    v_mul_f32 v19, v5, v8
    s_getreg_b32 s71, hwreg(HW_REG_IB_STS, 0, 4)
    s_or_b32 s71, s71, s73
    s_cbranch_scc1 L_nf_30
    s_call_b64 s[74:75], L_send1
L_nf_30:
    v_pk_mul_f32 v[30:31], v[10:11], v[10:11] op_sel:[0,0] op_sel_hi:[0,1]
    v_pk_fma_f32 v[12:13], v[10:11], v[10:11], v[30:31] op_sel:[1,1,0] op_sel_hi:[1,0,1] neg_lo:[0,1,0]
    v_pk_mul_f32 v[30:31], v[12:13], v[12:13] op_sel:[0,0] op_sel_hi:[0,1]
    v_pk_fma_f32 v[14:15], v[12:13], v[12:13], v[30:31] op_sel:[1,1,0] op_sel_hi:[1,0,1] neg_lo:[0,1,0]
    v_mov_b32 v133, 0x3f80
    v_pk_mul_f32 v[30:31], v[16:17], v[16:17] op_sel:[0,0] op_sel_hi:[0,1]
    v_cvt_pk_bf16_f32 v134, v16, v17
    v_pk_fma_f32 v[26:27], v[16:17], v[16:17], v[30:31] op_sel:[1,1,0] op_sel_hi:[1,0,1] neg_lo:[0,1,0]
    v_pk_mul_f32 v[30:31], v[26:27], v[16:17] op_sel:[0,0] op_sel_hi:[0,1]
    v_cvt_pk_bf16_f32 v135, v26, v27
    v_pk_fma_f32 v[28:29], v[26:27], v[16:17], v[30:31] op_sel:[1,1,0] op_sel_hi:[1,0,1] neg_lo:[0,1,0]
    v_pk_mul_f32 v[30:31], v[28:29], v[16:17] op_sel:[0,0] op_sel_hi:[0,1]
    v_cvt_pk_bf16_f32 v136, v28, v29
    v_pk_fma_f32 v[26:27], v[28:29], v[16:17], v[30:31] op_sel:[1,1,0] op_sel_hi:[1,0,1] neg_lo:[0,1,0]
    v_pk_mul_f32 v[30:31], v[26:27], v[16:17] op_sel:[0,0] op_sel_hi:[0,1]
    v_cvt_pk_bf16_f32 v137, v26, v27
    v_pk_fma_f32 v[28:29], v[26:27], v[16:17], v[30:31] op_sel:[1,1,0] op_sel_hi:[1,0,1] neg_lo:[0,1,0]
    v_pk_mul_f32 v[30:31], v[28:29], v[16:17] op_sel:[0,0] op_sel_hi:[0,1]
    v_cvt_pk_bf16_f32 v138, v28, v29
    v_pk_fma_f32 v[26:27], v[28:29], v[16:17], v[30:31] op_sel:[1,1,0] op_sel_hi:[1,0,1] neg_lo:[0,1,0]
    v_pk_mul_f32 v[30:31], v[26:27], v[16:17] op_sel:[0,0] op_sel_hi:[0,1]
    v_cvt_pk_bf16_f32 v139, v26, v27
    v_pk_fma_f32 v[28:29], v[26:27], v[16:17], v[30:31] op_sel:[1,1,0] op_sel_hi:[1,0,1] neg_lo:[0,1,0]
    v_pk_mul_f32 v[30:31], v[28:29], v[16:17] op_sel:[0,0] op_sel_hi:[0,1]
    v_cvt_pk_bf16_f32 v140, v28, v29
    v_pk_fma_f32 v[26:27], v[28:29], v[16:17], v[30:31] op_sel:[1,1,0] op_sel_hi:[1,0,1] neg_lo:[0,1,0]
    s_getreg_b32 s71, hwreg(HW_REG_IB_STS, 0, 4)
    s_or_b32 s71, s71, s73
    s_cbranch_scc1 L_nf_31
    s_call_b64 s[74:75], L_send1
L_nf_31:
    v_pk_mul_f32 v[30:31], v[26:27], v[16:17] op_sel:[0,0] op_sel_hi:[0,1]
    v_cvt_pk_bf16_f32 v141, v26, v27
    v_pk_fma_f32 v[28:29], v[26:27], v[16:17], v[30:31] op_sel:[1,1,0] op_sel_hi:[1,0,1] neg_lo:[0,1,0]
    v_pk_mul_f32 v[30:31], v[28:29], v[16:17] op_sel:[0,0] op_sel_hi:[0,1]
    v_cvt_pk_bf16_f32 v142, v28, v29
    v_pk_fma_f32 v[26:27], v[28:29], v[16:17], v[30:31] op_sel:[1,1,0] op_sel_hi:[1,0,1] neg_lo:[0,1,0]
    v_pk_mul_f32 v[30:31], v[26:27], v[16:17] op_sel:[0,0] op_sel_hi:[0,1]
    v_cvt_pk_bf16_f32 v143, v26, v27
    v_pk_fma_f32 v[28:29], v[26:27], v[16:17], v[30:31] op_sel:[1,1,0] op_sel_hi:[1,0,1] neg_lo:[0,1,0]
    v_pk_mul_f32 v[30:31], v[28:29], v[16:17] op_sel:[0,0] op_sel_hi:[0,1]
    v_cvt_pk_bf16_f32 v144, v28, v29
    v_pk_fma_f32 v[26:27], v[28:29], v[16:17], v[30:31] op_sel:[1,1,0] op_sel_hi:[1,0,1] neg_lo:[0,1,0]
    v_pk_mul_f32 v[30:31], v[26:27], v[16:17] op_sel:[0,0] op_sel_hi:[0,1]
    v_cvt_pk_bf16_f32 v145, v26, v27
    v_pk_fma_f32 v[28:29], v[26:27], v[16:17], v[30:31] op_sel:[1,1,0] op_sel_hi:[1,0,1] neg_lo:[0,1,0]
    v_pk_mul_f32 v[30:31], v[28:29], v[16:17] op_sel:[0,0] op_sel_hi:[0,1]
    v_cvt_pk_bf16_f32 v146, v28, v29
    v_pk_fma_f32 v[26:27], v[28:29], v[16:17], v[30:31] op_sel:[1,1,0] op_sel_hi:[1,0,1] neg_lo:[0,1,0]
    v_pk_mul_f32 v[30:31], v[26:27], v[16:17] op_sel:[0,0] op_sel_hi:[0,1]
    v_cvt_pk_bf16_f32 v147, v26, v27
    v_pk_fma_f32 v[28:29], v[26:27], v[16:17], v[30:31] op_sel:[1,1,0] op_sel_hi:[1,0,1] neg_lo:[0,1,0]
    v_cvt_pk_bf16_f32 v148, v28, v29
    v_pk_mul_f32 v[30:31], v[22:23], v[10:11] op_sel:[0,0] op_sel_hi:[0,1] neg_hi:[0,1]
    v_cvt_pk_bf16_f32 v149, v22, v23
    v_pk_fma_f32 v[28:29], v[22:23], v[10:11], v[30:31] op_sel:[1,1,0] op_sel_hi:[1,0,1]
    v_pk_mul_f32 v[30:31], v[28:29], v[10:11] op_sel:[0,0] op_sel_hi:[0,1] neg_hi:[0,1]
    v_cvt_pk_bf16_f32 v150, v28, v29
    v_pk_fma_f32 v[26:27], v[28:29], v[10:11], v[30:31] op_sel:[1,1,0] op_sel_hi:[1,0,1]
    s_getreg_b32 s71, hwreg(HW_REG_IB_STS, 0, 4)
    s_or_b32 s71, s71, s73
    s_cbranch_scc1 L_nf_32
    s_call_b64 s[74:75], L_send1
L_nf_32:
    v_pk_mul_f32 v[30:31], v[26:27], v[10:11] op_sel:[0,0] op_sel_hi:[0,1] neg_hi:[0,1]
    v_cvt_pk_bf16_f32 v151, v26, v27
    v_pk_fma_f32 v[28:29], v[26:27], v[10:11], v[30:31] op_sel:[1,1,0] op_sel_hi:[1,0,1]
    v_pk_mul_f32 v[30:31], v[28:29], v[10:11] op_sel:[0,0] op_sel_hi:[0,1] neg_hi:[0,1]
    v_cvt_pk_bf16_f32 v152, v28, v29
    v_pk_fma_f32 v[26:27], v[28:29], v[10:11], v[30:31] op_sel:[1,1,0] op_sel_hi:[1,0,1]
    v_pk_mul_f32 v[30:31], v[26:27], v[10:11] op_sel:[0,0] op_sel_hi:[0,1] neg_hi:[0,1]
    v_cvt_pk_bf16_f32 v153, v26, v27
    v_pk_fma_f32 v[28:29], v[26:27], v[10:11], v[30:31] op_sel:[1,1,0] op_sel_hi:[1,0,1]
    v_pk_mul_f32 v[30:31], v[28:29], v[10:11] op_sel:[0,0] op_sel_hi:[0,1] neg_hi:[0,1]
    v_cvt_pk_bf16_f32 v154, v28, v29
    v_pk_fma_f32 v[26:27], v[28:29], v[10:11], v[30:31] op_sel:[1,1,0] op_sel_hi:[1,0,1]
    v_pk_mul_f32 v[30:31], v[26:27], v[10:11] op_sel:[0,0] op_sel_hi:[0,1] neg_hi:[0,1]
    v_cvt_pk_bf16_f32 v155, v26, v27
    v_pk_fma_f32 v[28:29], v[26:27], v[10:11], v[30:31] op_sel:[1,1,0] op_sel_hi:[1,0,1]
    v_pk_mul_f32 v[30:31], v[22:23], v[18:19] op_sel:[0,0] op_sel_hi:[0,1] neg_hi:[0,1]
    v_cvt_pk_bf16_f32 v156, v28, v29
    v_pk_fma_f32 v[24:25], v[22:23], v[18:19], v[30:31] op_sel:[1,1,0] op_sel_hi:[1,0,1]
    v_pk_mul_f32 v[30:31], v[24:25], v[10:11] op_sel:[0,0] op_sel_hi:[0,1] neg_hi:[0,1]
    v_cvt_pk_bf16_f32 v157, v24, v25
    v_pk_fma_f32 v[28:29], v[24:25], v[10:11], v[30:31] op_sel:[1,1,0] op_sel_hi:[1,0,1]
    v_pk_mul_f32 v[30:31], v[28:29], v[10:11] op_sel:[0,0] op_sel_hi:[0,1] neg_hi:[0,1]
    v_cvt_pk_bf16_f32 v158, v28, v29
    v_pk_fma_f32 v[26:27], v[28:29], v[10:11], v[30:31] op_sel:[1,1,0] op_sel_hi:[1,0,1]
    v_pk_mul_f32 v[30:31], v[26:27], v[10:11] op_sel:[0,0] op_sel_hi:[0,1] neg_hi:[0,1]
    v_cvt_pk_bf16_f32 v159, v26, v27
    v_pk_fma_f32 v[28:29], v[26:27], v[10:11], v[30:31] op_sel:[1,1,0] op_sel_hi:[1,0,1]
    s_getreg_b32 s71, hwreg(HW_REG_IB_STS, 0, 4)
    s_or_b32 s71, s71, s73
    s_cbranch_scc1 L_nf_33
    s_call_b64 s[74:75], L_send1
L_nf_33:
    v_pk_mul_f32 v[30:31], v[28:29], v[10:11] op_sel:[0,0] op_sel_hi:[0,1] neg_hi:[0,1]
    v_cvt_pk_bf16_f32 v160, v28, v29
    v_pk_fma_f32 v[26:27], v[28:29], v[10:11], v[30:31] op_sel:[1,1,0] op_sel_hi:[1,0,1]
    v_pk_mul_f32 v[30:31], v[26:27], v[10:11] op_sel:[0,0] op_sel_hi:[0,1] neg_hi:[0,1]
    v_cvt_pk_bf16_f32 v161, v26, v27
    v_pk_fma_f32 v[28:29], v[26:27], v[10:11], v[30:31] op_sel:[1,1,0] op_sel_hi:[1,0,1]
    v_pk_mul_f32 v[30:31], v[28:29], v[10:11] op_sel:[0,0] op_sel_hi:[0,1] neg_hi:[0,1]
    v_cvt_pk_bf16_f32 v162, v28, v29
    v_pk_fma_f32 v[26:27], v[28:29], v[10:11], v[30:31] op_sel:[1,1,0] op_sel_hi:[1,0,1]
    v_pk_mul_f32 v[30:31], v[26:27], v[10:11] op_sel:[0,0] op_sel_hi:[0,1] neg_hi:[0,1]
    v_cvt_pk_bf16_f32 v163, v26, v27
    v_pk_fma_f32 v[28:29], v[26:27], v[10:11], v[30:31] op_sel:[1,1,0] op_sel_hi:[1,0,1]
    v_pk_mul_f32 v[30:31], v[24:25], v[18:19] op_sel:[0,0] op_sel_hi:[0,1] neg_hi:[0,1]
    v_cvt_pk_bf16_f32 v164, v28, v29
    v_pk_fma_f32 v[22:23], v[24:25], v[18:19], v[30:31] op_sel:[1,1,0] op_sel_hi:[1,0,1]
    v_pk_mul_f32 v[30:31], v[22:23], v[12:13] op_sel:[0,0] op_sel_hi:[0,1] neg_hi:[0,1]
    v_cvt_pk_bf16_f32 v165, v22, v23
    v_pk_fma_f32 v[28:29], v[22:23], v[12:13], v[30:31] op_sel:[1,1,0] op_sel_hi:[1,0,1]
    v_pk_mul_f32 v[30:31], v[28:29], v[12:13] op_sel:[0,0] op_sel_hi:[0,1] neg_hi:[0,1]
    v_cvt_pk_bf16_f32 v166, v28, v29
    v_pk_fma_f32 v[26:27], v[28:29], v[12:13], v[30:31] op_sel:[1,1,0] op_sel_hi:[1,0,1]
    v_pk_mul_f32 v[30:31], v[26:27], v[12:13] op_sel:[0,0] op_sel_hi:[0,1] neg_hi:[0,1]
    v_cvt_pk_bf16_f32 v167, v26, v27
    v_pk_fma_f32 v[28:29], v[26:27], v[12:13], v[30:31] op_sel:[1,1,0] op_sel_hi:[1,0,1]
    v_pk_mul_f32 v[30:31], v[22:23], v[18:19] op_sel:[0,0] op_sel_hi:[0,1] neg_hi:[0,1]
    v_cvt_pk_bf16_f32 v168, v28, v29
    v_pk_fma_f32 v[24:25], v[22:23], v[18:19], v[30:31] op_sel:[1,1,0] op_sel_hi:[1,0,1]
    s_getreg_b32 s71, hwreg(HW_REG_IB_STS, 0, 4)
    s_or_b32 s71, s71, s73
    s_cbranch_scc1 L_nf_34
    s_call_b64 s[74:75], L_send1
L_nf_34:
    v_pk_mul_f32 v[30:31], v[24:25], v[12:13] op_sel:[0,0] op_sel_hi:[0,1] neg_hi:[0,1]
    v_cvt_pk_bf16_f32 v169, v24, v25
    v_pk_fma_f32 v[28:29], v[24:25], v[12:13], v[30:31] op_sel:[1,1,0] op_sel_hi:[1,0,1]
    v_pk_mul_f32 v[30:31], v[28:29], v[12:13] op_sel:[0,0] op_sel_hi:[0,1] neg_hi:[0,1]
    v_cvt_pk_bf16_f32 v170, v28, v29
    v_pk_fma_f32 v[26:27], v[28:29], v[12:13], v[30:31] op_sel:[1,1,0] op_sel_hi:[1,0,1]
    v_pk_mul_f32 v[30:31], v[26:27], v[12:13] op_sel:[0,0] op_sel_hi:[0,1] neg_hi:[0,1]
    v_cvt_pk_bf16_f32 v171, v26, v27
    v_pk_fma_f32 v[28:29], v[26:27], v[12:13], v[30:31] op_sel:[1,1,0] op_sel_hi:[1,0,1]
    v_pk_mul_f32 v[30:31], v[24:25], v[18:19] op_sel:[0,0] op_sel_hi:[0,1] neg_hi:[0,1]
    v_cvt_pk_bf16_f32 v172, v28, v29
    v_pk_fma_f32 v[22:23], v[24:25], v[18:19], v[30:31] op_sel:[1,1,0] op_sel_hi:[1,0,1]
    v_pk_mul_f32 v[30:31], v[22:23], v[14:15] op_sel:[0,0] op_sel_hi:[0,1] neg_hi:[0,1]
    v_cvt_pk_bf16_f32 v173, v22, v23
    v_pk_fma_f32 v[28:29], v[22:23], v[14:15], v[30:31] op_sel:[1,1,0] op_sel_hi:[1,0,1]
    v_pk_mul_f32 v[30:31], v[22:23], v[18:19] op_sel:[0,0] op_sel_hi:[0,1] neg_hi:[0,1]
    v_cvt_pk_bf16_f32 v174, v28, v29
    v_pk_fma_f32 v[24:25], v[22:23], v[18:19], v[30:31] op_sel:[1,1,0] op_sel_hi:[1,0,1]
    v_pk_mul_f32 v[30:31], v[24:25], v[14:15] op_sel:[0,0] op_sel_hi:[0,1] neg_hi:[0,1]
    v_cvt_pk_bf16_f32 v175, v24, v25
    v_pk_fma_f32 v[28:29], v[24:25], v[14:15], v[30:31] op_sel:[1,1,0] op_sel_hi:[1,0,1]
    s_getreg_b32 s71, hwreg(HW_REG_IB_STS, 0, 4)
    s_or_b32 s71, s71, s73
    s_cbranch_scc1 L_nf_35
    s_call_b64 s[74:75], L_send1
L_nf_35:
    v_pk_mul_f32 v[30:31], v[24:25], v[18:19] op_sel:[0,0] op_sel_hi:[0,1] neg_hi:[0,1]
    v_cvt_pk_bf16_f32 v176, v28, v29
    v_pk_fma_f32 v[22:23], v[24:25], v[18:19], v[30:31] op_sel:[1,1,0] op_sel_hi:[1,0,1]
    v_pk_mul_f32 v[30:31], v[22:23], v[14:15] op_sel:[0,0] op_sel_hi:[0,1] neg_hi:[0,1]
    v_cvt_pk_bf16_f32 v177, v22, v23
    v_pk_fma_f32 v[28:29], v[22:23], v[14:15], v[30:31] op_sel:[1,1,0] op_sel_hi:[1,0,1]
    v_pk_mul_f32 v[30:31], v[22:23], v[18:19] op_sel:[0,0] op_sel_hi:[0,1] neg_hi:[0,1]
    v_cvt_pk_bf16_f32 v178, v28, v29
    v_pk_fma_f32 v[24:25], v[22:23], v[18:19], v[30:31] op_sel:[1,1,0] op_sel_hi:[1,0,1]
    v_pk_mul_f32 v[30:31], v[24:25], v[14:15] op_sel:[0,0] op_sel_hi:[0,1] neg_hi:[0,1]
    v_cvt_pk_bf16_f32 v179, v24, v25
    v_pk_fma_f32 v[28:29], v[24:25], v[14:15], v[30:31] op_sel:[1,1,0] op_sel_hi:[1,0,1]
    v_pk_mul_f32 v[30:31], v[24:25], v[18:19] op_sel:[0,0] op_sel_hi:[0,1] neg_hi:[0,1]
    v_cvt_pk_bf16_f32 v180, v28, v29
    v_pk_fma_f32 v[22:23], v[24:25], v[18:19], v[30:31] op_sel:[1,1,0] op_sel_hi:[1,0,1]
    v_pk_mul_f32 v[30:31], v[22:23], v[18:19] op_sel:[0,0] op_sel_hi:[0,1] neg_hi:[0,1]
    v_cvt_pk_bf16_f32 v181, v22, v23
    v_pk_fma_f32 v[24:25], v[22:23], v[18:19], v[30:31] op_sel:[1,1,0] op_sel_hi:[1,0,1]
    s_getreg_b32 s71, hwreg(HW_REG_IB_STS, 0, 4)
    s_or_b32 s71, s71, s73
    s_cbranch_scc1 L_nf_36
    s_call_b64 s[74:75], L_send1
L_nf_36:
    v_pk_mul_f32 v[30:31], v[24:25], v[18:19] op_sel:[0,0] op_sel_hi:[0,1] neg_hi:[0,1]
    v_cvt_pk_bf16_f32 v182, v24, v25
    v_pk_fma_f32 v[22:23], v[24:25], v[18:19], v[30:31] op_sel:[1,1,0] op_sel_hi:[1,0,1]
    v_pk_mul_f32 v[30:31], v[22:23], v[18:19] op_sel:[0,0] op_sel_hi:[0,1] neg_hi:[0,1]
    v_cvt_pk_bf16_f32 v183, v22, v23
    v_pk_fma_f32 v[24:25], v[22:23], v[18:19], v[30:31] op_sel:[1,1,0] op_sel_hi:[1,0,1]
    v_pk_mul_f32 v[30:31], v[24:25], v[18:19] op_sel:[0,0] op_sel_hi:[0,1] neg_hi:[0,1]
    v_cvt_pk_bf16_f32 v184, v24, v25
    v_pk_fma_f32 v[22:23], v[24:25], v[18:19], v[30:31] op_sel:[1,1,0] op_sel_hi:[1,0,1]
    v_pk_mul_f32 v[30:31], v[22:23], v[18:19] op_sel:[0,0] op_sel_hi:[0,1] neg_hi:[0,1]
    v_cvt_pk_bf16_f32 v185, v22, v23
    v_pk_fma_f32 v[24:25], v[22:23], v[18:19], v[30:31] op_sel:[1,1,0] op_sel_hi:[1,0,1]
    v_pk_mul_f32 v[30:31], v[24:25], v[18:19] op_sel:[0,0] op_sel_hi:[0,1] neg_hi:[0,1]
    v_cvt_pk_bf16_f32 v186, v24, v25
    v_pk_fma_f32 v[22:23], v[24:25], v[18:19], v[30:31] op_sel:[1,1,0] op_sel_hi:[1,0,1]
    s_getreg_b32 s71, hwreg(HW_REG_IB_STS, 0, 4)
    s_or_b32 s71, s71, s73
    s_cbranch_scc1 L_nf_37
    s_call_b64 s[74:75], L_send1
L_nf_37:
    v_pk_mul_f32 v[30:31], v[22:23], v[18:19] op_sel:[0,0] op_sel_hi:[0,1] neg_hi:[0,1]
    v_cvt_pk_bf16_f32 v187, v22, v23
    v_pk_fma_f32 v[24:25], v[22:23], v[18:19], v[30:31] op_sel:[1,1,0] op_sel_hi:[1,0,1]
    v_pk_mul_f32 v[30:31], v[24:25], v[18:19] op_sel:[0,0] op_sel_hi:[0,1] neg_hi:[0,1]
    v_cvt_pk_bf16_f32 v188, v24, v25
    v_pk_fma_f32 v[22:23], v[24:25], v[18:19], v[30:31] op_sel:[1,1,0] op_sel_hi:[1,0,1]
    v_cvt_pk_bf16_f32 v189, v22, v23
    v_lshlrev_b32 v5, 16, v246
    v_lshlrev_b32 v6, 16, v247
    v_lshlrev_b32 v7, 16, v248
    v_lshlrev_b32 v8, 16, v249
    v_mul_f32 v20, v1, v5
    v_exp_f32 v20, v20
    v_mul_f32 v21, v6, v2
    v_mul_f32 v21, 0.15915494, v21
    v_cvt_pk_bf16_f32 v20, v20, v20
    v_and_b32 v20, s67, v20
    v_mul_f32 v20, v20, v2
    v_mul_f32 v20, v20, v1
    v_add_f32 v5, v2, v2
    v_mul_f32_e64 v22, v7, v5
    v_mul_f32 v23, -v8, v5
    v_mul_f32 v5, 0xbf800000, v20
    v_mul_f32 v6, 0x3f800000, v21
    v_exp_f32 v5, v5
    v_fract_f32 v6, v6
    v_cos_f32 v7, v6
    v_sin_f32 v8, v6
    v_mul_f32 v10, v5, v7
    v_mul_f32 v11, v5, v8
    v_mul_f32 v5, 0xc1000000, v20
    v_mul_f32 v6, 0x41000000, v21
    v_exp_f32 v5, v5
    v_fract_f32 v6, v6
    v_cos_f32 v7, v6
    v_sin_f32 v8, v6
    v_mul_f32 v16, v5, v7
    v_mul_f32 v17, v5, v8
    v_mul_f32 v5, 0xc3000000, v20
    v_mul_f32 v6, 0x43000000, v21
    v_exp_f32 v5, v5
    v_fract_f32 v6, v6
    v_cos_f32 v7, v6
    v_sin_f32 v8, v6
    v_mul_f32 v18, v5, v7
    v_mul_f32 v19, v5, v8
    s_getreg_b32 s71, hwreg(HW_REG_IB_STS, 0, 4)
    s_or_b32 s71, s71, s73
    s_cbranch_scc1 L_nf_38
    s_call_b64 s[74:75], L_send1
L_nf_38:
    v_pk_mul_f32 v[30:31], v[10:11], v[10:11] op_sel:[0,0] op_sel_hi:[0,1]
    v_pk_fma_f32 v[12:13], v[10:11], v[10:11], v[30:31] op_sel:[1,1,0] op_sel_hi:[1,0,1] neg_lo:[0,1,0]
    v_pk_mul_f32 v[30:31], v[12:13], v[12:13] op_sel:[0,0] op_sel_hi:[0,1]
    v_pk_fma_f32 v[14:15], v[12:13], v[12:13], v[30:31] op_sel:[1,1,0] op_sel_hi:[1,0,1] neg_lo:[0,1,0]
    v_mov_b32 v190, 0x3f80
    v_pk_mul_f32 v[30:31], v[16:17], v[16:17] op_sel:[0,0] op_sel_hi:[0,1]
    v_cvt_pk_bf16_f32 v191, v16, v17
    v_pk_fma_f32 v[26:27], v[16:17], v[16:17], v[30:31] op_sel:[1,1,0] op_sel_hi:[1,0,1] neg_lo:[0,1,0]
    v_pk_mul_f32 v[30:31], v[26:27], v[16:17] op_sel:[0,0] op_sel_hi:[0,1]
    v_cvt_pk_bf16_f32 v192, v26, v27
    v_pk_fma_f32 v[28:29], v[26:27], v[16:17], v[30:31] op_sel:[1,1,0] op_sel_hi:[1,0,1] neg_lo:[0,1,0]
    v_pk_mul_f32 v[30:31], v[28:29], v[16:17] op_sel:[0,0] op_sel_hi:[0,1]
    v_cvt_pk_bf16_f32 v193, v28, v29
    v_pk_fma_f32 v[26:27], v[28:29], v[16:17], v[30:31] op_sel:[1,1,0] op_sel_hi:[1,0,1] neg_lo:[0,1,0]
    v_pk_mul_f32 v[30:31], v[26:27], v[16:17] op_sel:[0,0] op_sel_hi:[0,1]
    v_cvt_pk_bf16_f32 v194, v26, v27
    v_pk_fma_f32 v[28:29], v[26:27], v[16:17], v[30:31] op_sel:[1,1,0] op_sel_hi:[1,0,1] neg_lo:[0,1,0]
    v_pk_mul_f32 v[30:31], v[28:29], v[16:17] op_sel:[0,0] op_sel_hi:[0,1]
    v_cvt_pk_bf16_f32 v195, v28, v29
    v_pk_fma_f32 v[26:27], v[28:29], v[16:17], v[30:31] op_sel:[1,1,0] op_sel_hi:[1,0,1] neg_lo:[0,1,0]
    v_pk_mul_f32 v[30:31], v[26:27], v[16:17] op_sel:[0,0] op_sel_hi:[0,1]
    v_cvt_pk_bf16_f32 v196, v26, v27
    v_pk_fma_f32 v[28:29], v[26:27], v[16:17], v[30:31] op_sel:[1,1,0] op_sel_hi:[1,0,1] neg_lo:[0,1,0]
    v_pk_mul_f32 v[30:31], v[28:29], v[16:17] op_sel:[0,0] op_sel_hi:[0,1]
    v_cvt_pk_bf16_f32 v197, v28, v29
    v_pk_fma_f32 v[26:27], v[28:29], v[16:17], v[30:31] op_sel:[1,1,0] op_sel_hi:[1,0,1] neg_lo:[0,1,0]
    s_getreg_b32 s71, hwreg(HW_REG_IB_STS, 0, 4)
    s_or_b32 s71, s71, s73
    s_cbranch_scc1 L_nf_39
    s_call_b64 s[74:75], L_send1
L_nf_39:
    v_pk_mul_f32 v[30:31], v[26:27], v[16:17] op_sel:[0,0] op_sel_hi:[0,1]
    v_cvt_pk_bf16_f32 v198, v26, v27
    v_pk_fma_f32 v[28:29], v[26:27], v[16:17], v[30:31] op_sel:[1,1,0] op_sel_hi:[1,0,1] neg_lo:[0,1,0]
    v_pk_mul_f32 v[30:31], v[28:29], v[16:17] op_sel:[0,0] op_sel_hi:[0,1]
    v_cvt_pk_bf16_f32 v199, v28, v29
    v_pk_fma_f32 v[26:27], v[28:29], v[16:17], v[30:31] op_sel:[1,1,0] op_sel_hi:[1,0,1] neg_lo:[0,1,0]
    v_pk_mul_f32 v[30:31], v[26:27], v[16:17] op_sel:[0,0] op_sel_hi:[0,1]
    v_cvt_pk_bf16_f32 v200, v26, v27
    v_pk_fma_f32 v[28:29], v[26:27], v[16:17], v[30:31] op_sel:[1,1,0] op_sel_hi:[1,0,1] neg_lo:[0,1,0]
    v_pk_mul_f32 v[30:31], v[28:29], v[16:17] op_sel:[0,0] op_sel_hi:[0,1]
    v_cvt_pk_bf16_f32 v201, v28, v29
    v_pk_fma_f32 v[26:27], v[28:29], v[16:17], v[30:31] op_sel:[1,1,0] op_sel_hi:[1,0,1] neg_lo:[0,1,0]
    v_pk_mul_f32 v[30:31], v[26:27], v[16:17] op_sel:[0,0] op_sel_hi:[0,1]
    v_cvt_pk_bf16_f32 v202, v26, v27
    v_pk_fma_f32 v[28:29], v[26:27], v[16:17], v[30:31] op_sel:[1,1,0] op_sel_hi:[1,0,1] neg_lo:[0,1,0]
    v_pk_mul_f32 v[30:31], v[28:29], v[16:17] op_sel:[0,0] op_sel_hi:[0,1]
    v_cvt_pk_bf16_f32 v203, v28, v29
    v_pk_fma_f32 v[26:27], v[28:29], v[16:17], v[30:31] op_sel:[1,1,0] op_sel_hi:[1,0,1] neg_lo:[0,1,0]
    v_pk_mul_f32 v[30:31], v[26:27], v[16:17] op_sel:[0,0] op_sel_hi:[0,1]
    v_cvt_pk_bf16_f32 v204, v26, v27
    v_pk_fma_f32 v[28:29], v[26:27], v[16:17], v[30:31] op_sel:[1,1,0] op_sel_hi:[1,0,1] neg_lo:[0,1,0]
    v_cvt_pk_bf16_f32 v205, v28, v29
    v_pk_mul_f32 v[30:31], v[22:23], v[10:11] op_sel:[0,0] op_sel_hi:[0,1] neg_hi:[0,1]
    v_cvt_pk_bf16_f32 v206, v22, v23
    v_pk_fma_f32 v[28:29], v[22:23], v[10:11], v[30:31] op_sel:[1,1,0] op_sel_hi:[1,0,1]
    v_pk_mul_f32 v[30:31], v[28:29], v[10:11] op_sel:[0,0] op_sel_hi:[0,1] neg_hi:[0,1]
    v_cvt_pk_bf16_f32 v207, v28, v29
    v_pk_fma_f32 v[26:27], v[28:29], v[10:11], v[30:31] op_sel:[1,1,0] op_sel_hi:[1,0,1]
    s_getreg_b32 s71, hwreg(HW_REG_IB_STS, 0, 4)
    s_or_b32 s71, s71, s73
    s_cbranch_scc1 L_nf_40
    s_call_b64 s[74:75], L_send1
L_nf_40:
    v_pk_mul_f32 v[30:31], v[26:27], v[10:11] op_sel:[0,0] op_sel_hi:[0,1] neg_hi:[0,1]
    v_cvt_pk_bf16_f32 v208, v26, v27
    v_pk_fma_f32 v[28:29], v[26:27], v[10:11], v[30:31] op_sel:[1,1,0] op_sel_hi:[1,0,1]
    v_pk_mul_f32 v[30:31], v[28:29], v[10:11] op_sel:[0,0] op_sel_hi:[0,1] neg_hi:[0,1]
    v_cvt_pk_bf16_f32 v209, v28, v29
    v_pk_fma_f32 v[26:27], v[28:29], v[10:11], v[30:31] op_sel:[1,1,0] op_sel_hi:[1,0,1]
    v_pk_mul_f32 v[30:31], v[26:27], v[10:11] op_sel:[0,0] op_sel_hi:[0,1] neg_hi:[0,1]
    v_cvt_pk_bf16_f32 v210, v26, v27
    v_pk_fma_f32 v[28:29], v[26:27], v[10:11], v[30:31] op_sel:[1,1,0] op_sel_hi:[1,0,1]
    v_pk_mul_f32 v[30:31], v[28:29], v[10:11] op_sel:[0,0] op_sel_hi:[0,1] neg_hi:[0,1]
    v_cvt_pk_bf16_f32 v211, v28, v29
    v_pk_fma_f32 v[26:27], v[28:29], v[10:11], v[30:31] op_sel:[1,1,0] op_sel_hi:[1,0,1]
    v_pk_mul_f32 v[30:31], v[26:27], v[10:11] op_sel:[0,0] op_sel_hi:[0,1] neg_hi:[0,1]
    v_cvt_pk_bf16_f32 v212, v26, v27
    v_pk_fma_f32 v[28:29], v[26:27], v[10:11], v[30:31] op_sel:[1,1,0] op_sel_hi:[1,0,1]
    v_pk_mul_f32 v[30:31], v[22:23], v[18:19] op_sel:[0,0] op_sel_hi:[0,1] neg_hi:[0,1]
    v_cvt_pk_bf16_f32 v213, v28, v29
    v_pk_fma_f32 v[24:25], v[22:23], v[18:19], v[30:31] op_sel:[1,1,0] op_sel_hi:[1,0,1]
    v_pk_mul_f32 v[30:31], v[24:25], v[10:11] op_sel:[0,0] op_sel_hi:[0,1] neg_hi:[0,1]
    v_cvt_pk_bf16_f32 v214, v24, v25
    v_pk_fma_f32 v[28:29], v[24:25], v[10:11], v[30:31] op_sel:[1,1,0] op_sel_hi:[1,0,1]
    v_pk_mul_f32 v[30:31], v[28:29], v[10:11] op_sel:[0,0] op_sel_hi:[0,1] neg_hi:[0,1]
    v_cvt_pk_bf16_f32 v215, v28, v29
    v_pk_fma_f32 v[26:27], v[28:29], v[10:11], v[30:31] op_sel:[1,1,0] op_sel_hi:[1,0,1]
    v_pk_mul_f32 v[30:31], v[26:27], v[10:11] op_sel:[0,0] op_sel_hi:[0,1] neg_hi:[0,1]
    v_cvt_pk_bf16_f32 v216, v26, v27
    v_pk_fma_f32 v[28:29], v[26:27], v[10:11], v[30:31] op_sel:[1,1,0] op_sel_hi:[1,0,1]
    s_getreg_b32 s71, hwreg(HW_REG_IB_STS, 0, 4)
    s_or_b32 s71, s71, s73
    s_cbranch_scc1 L_nf_41
    s_call_b64 s[74:75], L_send1
L_nf_41:
    v_pk_mul_f32 v[30:31], v[28:29], v[10:11] op_sel:[0,0] op_sel_hi:[0,1] neg_hi:[0,1]
    v_cvt_pk_bf16_f32 v217, v28, v29
    v_pk_fma_f32 v[26:27], v[28:29], v[10:11], v[30:31] op_sel:[1,1,0] op_sel_hi:[1,0,1]
    v_pk_mul_f32 v[30:31], v[26:27], v[10:11] op_sel:[0,0] op_sel_hi:[0,1] neg_hi:[0,1]
    v_cvt_pk_bf16_f32 v218, v26, v27
    v_pk_fma_f32 v[28:29], v[26:27], v[10:11], v[30:31] op_sel:[1,1,0] op_sel_hi:[1,0,1]
    v_pk_mul_f32 v[30:31], v[28:29], v[10:11] op_sel:[0,0] op_sel_hi:[0,1] neg_hi:[0,1]
    v_cvt_pk_bf16_f32 v219, v28, v29
    v_pk_fma_f32 v[26:27], v[28:29], v[10:11], v[30:31] op_sel:[1,1,0] op_sel_hi:[1,0,1]
    v_pk_mul_f32 v[30:31], v[26:27], v[10:11] op_sel:[0,0] op_sel_hi:[0,1] neg_hi:[0,1]
    v_cvt_pk_bf16_f32 v220, v26, v27
    v_pk_fma_f32 v[28:29], v[26:27], v[10:11], v[30:31] op_sel:[1,1,0] op_sel_hi:[1,0,1]
    v_pk_mul_f32 v[30:31], v[24:25], v[18:19] op_sel:[0,0] op_sel_hi:[0,1] neg_hi:[0,1]
    v_cvt_pk_bf16_f32 v221, v28, v29
    v_pk_fma_f32 v[22:23], v[24:25], v[18:19], v[30:31] op_sel:[1,1,0] op_sel_hi:[1,0,1]
    v_pk_mul_f32 v[30:31], v[22:23], v[12:13] op_sel:[0,0] op_sel_hi:[0,1] neg_hi:[0,1]
    v_cvt_pk_bf16_f32 v222, v22, v23
    v_pk_fma_f32 v[28:29], v[22:23], v[12:13], v[30:31] op_sel:[1,1,0] op_sel_hi:[1,0,1]
    v_pk_mul_f32 v[30:31], v[28:29], v[12:13] op_sel:[0,0] op_sel_hi:[0,1] neg_hi:[0,1]
    v_cvt_pk_bf16_f32 v223, v28, v29
    v_pk_fma_f32 v[26:27], v[28:29], v[12:13], v[30:31] op_sel:[1,1,0] op_sel_hi:[1,0,1]
    v_pk_mul_f32 v[30:31], v[26:27], v[12:13] op_sel:[0,0] op_sel_hi:[0,1] neg_hi:[0,1]
    v_cvt_pk_bf16_f32 v224, v26, v27
    v_pk_fma_f32 v[28:29], v[26:27], v[12:13], v[30:31] op_sel:[1,1,0] op_sel_hi:[1,0,1]
    v_pk_mul_f32 v[30:31], v[22:23], v[18:19] op_sel:[0,0] op_sel_hi:[0,1] neg_hi:[0,1]
    v_cvt_pk_bf16_f32 v225, v28, v29
    v_pk_fma_f32 v[24:25], v[22:23], v[18:19], v[30:31] op_sel:[1,1,0] op_sel_hi:[1,0,1]
    s_getreg_b32 s71, hwreg(HW_REG_IB_STS, 0, 4)
    s_or_b32 s71, s71, s73
    s_cbranch_scc1 L_nf_42
    s_call_b64 s[74:75], L_send1
L_nf_42:
    v_pk_mul_f32 v[30:31], v[24:25], v[12:13] op_sel:[0,0] op_sel_hi:[0,1] neg_hi:[0,1]
    v_cvt_pk_bf16_f32 v226, v24, v25
    v_pk_fma_f32 v[28:29], v[24:25], v[12:13], v[30:31] op_sel:[1,1,0] op_sel_hi:[1,0,1]
    v_pk_mul_f32 v[30:31], v[28:29], v[12:13] op_sel:[0,0] op_sel_hi:[0,1] neg_hi:[0,1]
    v_cvt_pk_bf16_f32 v227, v28, v29
    v_pk_fma_f32 v[26:27], v[28:29], v[12:13], v[30:31] op_sel:[1,1,0] op_sel_hi:[1,0,1]
    v_pk_mul_f32 v[30:31], v[26:27], v[12:13] op_sel:[0,0] op_sel_hi:[0,1] neg_hi:[0,1]
    v_cvt_pk_bf16_f32 v228, v26, v27
    v_pk_fma_f32 v[28:29], v[26:27], v[12:13], v[30:31] op_sel:[1,1,0] op_sel_hi:[1,0,1]
    v_pk_mul_f32 v[30:31], v[24:25], v[18:19] op_sel:[0,0] op_sel_hi:[0,1] neg_hi:[0,1]
    v_cvt_pk_bf16_f32 v229, v28, v29
    v_pk_fma_f32 v[22:23], v[24:25], v[18:19], v[30:31] op_sel:[1,1,0] op_sel_hi:[1,0,1]
    v_pk_mul_f32 v[30:31], v[22:23], v[14:15] op_sel:[0,0] op_sel_hi:[0,1] neg_hi:[0,1]
    v_cvt_pk_bf16_f32 v230, v22, v23
    v_pk_fma_f32 v[28:29], v[22:23], v[14:15], v[30:31] op_sel:[1,1,0] op_sel_hi:[1,0,1]
    v_pk_mul_f32 v[30:31], v[22:23], v[18:19] op_sel:[0,0] op_sel_hi:[0,1] neg_hi:[0,1]
    v_cvt_pk_bf16_f32 v231, v28, v29
    v_pk_fma_f32 v[24:25], v[22:23], v[18:19], v[30:31] op_sel:[1,1,0] op_sel_hi:[1,0,1]
    v_pk_mul_f32 v[30:31], v[24:25], v[14:15] op_sel:[0,0] op_sel_hi:[0,1] neg_hi:[0,1]
    v_cvt_pk_bf16_f32 v232, v24, v25
    v_pk_fma_f32 v[28:29], v[24:25], v[14:15], v[30:31] op_sel:[1,1,0] op_sel_hi:[1,0,1]
    s_getreg_b32 s71, hwreg(HW_REG_IB_STS, 0, 4)
    s_or_b32 s71, s71, s73
    s_cbranch_scc1 L_nf_43
    s_call_b64 s[74:75], L_send1
L_nf_43:
    v_pk_mul_f32 v[30:31], v[24:25], v[18:19] op_sel:[0,0] op_sel_hi:[0,1] neg_hi:[0,1]
    v_cvt_pk_bf16_f32 v233, v28, v29
    v_pk_fma_f32 v[22:23], v[24:25], v[18:19], v[30:31] op_sel:[1,1,0] op_sel_hi:[1,0,1]
    v_pk_mul_f32 v[30:31], v[22:23], v[14:15] op_sel:[0,0] op_sel_hi:[0,1] neg_hi:[0,1]
    v_cvt_pk_bf16_f32 v234, v22, v23
    v_pk_fma_f32 v[28:29], v[22:23], v[14:15], v[30:31] op_sel:[1,1,0] op_sel_hi:[1,0,1]
    v_pk_mul_f32 v[30:31], v[22:23], v[18:19] op_sel:[0,0] op_sel_hi:[0,1] neg_hi:[0,1]
    v_cvt_pk_bf16_f32 v235, v28, v29
    v_pk_fma_f32 v[24:25], v[22:23], v[18:19], v[30:31] op_sel:[1,1,0] op_sel_hi:[1,0,1]
    v_pk_mul_f32 v[30:31], v[24:25], v[14:15] op_sel:[0,0] op_sel_hi:[0,1] neg_hi:[0,1]
    v_cvt_pk_bf16_f32 v236, v24, v25
    v_pk_fma_f32 v[28:29], v[24:25], v[14:15], v[30:31] op_sel:[1,1,0] op_sel_hi:[1,0,1]
    v_pk_mul_f32 v[30:31], v[24:25], v[18:19] op_sel:[0,0] op_sel_hi:[0,1] neg_hi:[0,1]
    v_cvt_pk_bf16_f32 v237, v28, v29
    v_pk_fma_f32 v[22:23], v[24:25], v[18:19], v[30:31] op_sel:[1,1,0] op_sel_hi:[1,0,1]
    v_pk_mul_f32 v[30:31], v[22:23], v[18:19] op_sel:[0,0] op_sel_hi:[0,1] neg_hi:[0,1]
    v_cvt_pk_bf16_f32 v238, v22, v23
    v_pk_fma_f32 v[24:25], v[22:23], v[18:19], v[30:31] op_sel:[1,1,0] op_sel_hi:[1,0,1]
    s_getreg_b32 s71, hwreg(HW_REG_IB_STS, 0, 4)
    s_or_b32 s71, s71, s73
    s_cbranch_scc1 L_nf_44
    s_call_b64 s[74:75], L_send1
L_nf_44:
    v_pk_mul_f32 v[30:31], v[24:25], v[18:19] op_sel:[0,0] op_sel_hi:[0,1] neg_hi:[0,1]
    v_cvt_pk_bf16_f32 v239, v24, v25
    v_pk_fma_f32 v[22:23], v[24:25], v[18:19], v[30:31] op_sel:[1,1,0] op_sel_hi:[1,0,1]
    v_pk_mul_f32 v[30:31], v[22:23], v[18:19] op_sel:[0,0] op_sel_hi:[0,1] neg_hi:[0,1]
    v_cvt_pk_bf16_f32 v240, v22, v23
    v_pk_fma_f32 v[24:25], v[22:23], v[18:19], v[30:31] op_sel:[1,1,0] op_sel_hi:[1,0,1]
    v_pk_mul_f32 v[30:31], v[24:25], v[18:19] op_sel:[0,0] op_sel_hi:[0,1] neg_hi:[0,1]
    v_cvt_pk_bf16_f32 v241, v24, v25
    v_pk_fma_f32 v[22:23], v[24:25], v[18:19], v[30:31] op_sel:[1,1,0] op_sel_hi:[1,0,1]
    v_pk_mul_f32 v[30:31], v[22:23], v[18:19] op_sel:[0,0] op_sel_hi:[0,1] neg_hi:[0,1]
    v_cvt_pk_bf16_f32 v242, v22, v23
    v_pk_fma_f32 v[24:25], v[22:23], v[18:19], v[30:31] op_sel:[1,1,0] op_sel_hi:[1,0,1]
    v_pk_mul_f32 v[30:31], v[24:25], v[18:19] op_sel:[0,0] op_sel_hi:[0,1] neg_hi:[0,1]
    v_cvt_pk_bf16_f32 v243, v24, v25
    v_pk_fma_f32 v[22:23], v[24:25], v[18:19], v[30:31] op_sel:[1,1,0] op_sel_hi:[1,0,1]
    s_getreg_b32 s71, hwreg(HW_REG_IB_STS, 0, 4)
    s_or_b32 s71, s71, s73
    s_cbranch_scc1 L_nf_45
    s_call_b64 s[74:75], L_send1
L_nf_45:
    v_pk_mul_f32 v[30:31], v[22:23], v[18:19] op_sel:[0,0] op_sel_hi:[0,1] neg_hi:[0,1]
    v_cvt_pk_bf16_f32 v244, v22, v23
    v_pk_fma_f32 v[24:25], v[22:23], v[18:19], v[30:31] op_sel:[1,1,0] op_sel_hi:[1,0,1]
    v_pk_mul_f32 v[30:31], v[24:25], v[18:19] op_sel:[0,0] op_sel_hi:[0,1] neg_hi:[0,1]
    v_cvt_pk_bf16_f32 v245, v24, v25
    v_pk_fma_f32 v[22:23], v[24:25], v[18:19], v[30:31] op_sel:[1,1,0] op_sel_hi:[1,0,1]
    v_cvt_pk_bf16_f32 v246, v22, v23
L_kg_fin:
    s_cmp_lg_u32 s73, 0
    s_cbranch_scc1 L_kg_sent
    s_waitcnt vmcnt(0)
    s_call_b64 s[74:75], L_send1
    s_branch L_kg_fin
L_kg_sent:
    v_and_b32 v5, 15, v0
    v_lshrrev_b32 v6, 4, v0
    v_lshrrev_b32 v7, 3, v5
    v_add_u32 v7, 2, v7
    v_lshrrev_b32 v4, 16, v4
    v_and_b32 v8, 1, v5
    v_lshlrev_b32 v8, 4, v8
    v_lshlrev_b32 v4, v8, v4
    v_cmp_eq_u32 vcc, v6, v7
    s_nop 1
    v_cndmask_b32 v4, 0, v4, vcc
    v_bfe_u32 v7, v5, 1, 2
    v_cmp_eq_u32 vcc, 0, v7
    s_nop 1
    v_cndmask_b32 v56, 0, v4, vcc
    v_cmp_eq_u32 vcc, 1, v7
    s_nop 1
    v_cndmask_b32 v57, 0, v4, vcc
    v_cmp_eq_u32 vcc, 2, v7
    s_nop 1
    v_cndmask_b32 v58, 0, v4, vcc
    v_cmp_eq_u32 vcc, 3, v7
    s_nop 1
    v_cndmask_b32 v59, 0, v4, vcc
    v_lshlrev_b32_e64 v5, 4, v5
    v_lshl_add_u32 v5, v6, 2, v5
    v_add_u32_e64 v8, s78, v5
    v_bfe_u32 v5, v0, 2, 2
    v_and_b32_e64 v7, 3, v0
    v_mul_u32_u24 v5, 4608, v5
    v_lshl_add_u32 v5, v6, 5, v5
    v_lshl_add_u32 v5, v7, 3, v5
    s_lshl_b32 s72, s59, 9
    s_add_u32 s72, s72, 256
    v_add_u32 v4, s72, v5
    v_and_b32 v5, 15, v0
    v_lshlrev_b32 v7, 3, v6
    v_sub_u32 v5, v5, v7
    v_add_u32 v7, 37, v5
    v_mov_b32 v22, 0x7f
    v_mov_b32_e64 v23, 0
    v_lshlrev_b64 v[22:23], v7, v[22:23]
    v_bfe_u32 v7, v23, 0, 1
    v_bfe_u32 v22, v23, 1, 1
    v_lshl_or_b32 v7, v22, 16, v7
    v_mul_u32_u24 v248, 0x3f80, v7
    v_bfe_u32 v7, v23, 2, 1
    v_bfe_u32 v22, v23, 3, 1
    v_lshl_or_b32 v7, v22, 16, v7
    v_mul_u32_u24 v249, 0x3f80, v7
    v_bfe_u32 v7, v23, 4, 1
    v_bfe_u32 v22, v23, 5, 1
    v_lshl_or_b32 v7, v22, 16, v7
    v_mul_u32_u24 v250, 0x3f80, v7
    v_bfe_u32 v7, v23, 6, 1
    v_bfe_u32 v22, v23, 7, 1
    v_lshl_or_b32 v7, v22, 16, v7
    v_mul_u32_u24 v251, 0x3f80, v7
    v_add_u32_e64 v7, 36, v5
    v_mov_b32 v22, 0x1ff
    v_mov_b32_e64 v23, 0
    v_lshlrev_b64 v[22:23], v7, v[22:23]
    v_bfe_u32 v7, v23, 0, 1
    v_bfe_u32 v22, v23, 1, 1
    v_lshl_or_b32 v7, v22, 16, v7
    v_mul_u32_u24 v252, 0x3f80, v7
    v_bfe_u32 v7, v23, 2, 1
    v_bfe_u32 v22, v23, 3, 1
    v_lshl_or_b32 v7, v22, 16, v7
    v_mul_u32_u24 v253, 0x3f80, v7
    v_bfe_u32 v7, v23, 4, 1
    v_bfe_u32 v22, v23, 5, 1
    v_lshl_or_b32 v7, v22, 16, v7
    v_mul_u32_u24 v254, 0x3f80, v7
    v_bfe_u32 v7, v23, 6, 1
    v_bfe_u32 v22, v23, 7, 1
    v_lshl_or_b32 v7, v22, 16, v7
    v_mul_u32_u24 v255, 0x3f80, v7
    v_mov_b32 v1, 0
    v_mov_b32_e64 v3, 1
    s_lshl_b32 s71, s63, 14
    s_lshl_b32 s72, s59, 12
    s_add_u32 s73, s71, s72
    s_add_u32 s71, s73, 0x400000
    s_add_u32 s73, s73, 0xa00000
    v_lshlrev_b32 v5, 4, v0
    v_and_b32 v6, 3, v0
    v_mul_u32_u24 v6, 4640, v6
    v_lshrrev_b32_e64 v7, 2, v0
    v_lshl_add_u32 v6, v7, 4, v6
    s_lshl_b32 s72, s59, 10
    s_add_u32 s72, s72, 19200
    v_add_u32 v6, s72, v6
    s_sub_u32 s72, s77, 480
    v_add_u32 v9, s72, v5
    v_lshlrev_b32 v2, 4, v0
    s_mul_i32 s72, s59, 160
    s_add_u32 s72, s72, s63
    s_lshl_b32 s72, s72, 3
    s_add_u32 s72, s72, 0x50000
    s_mov_b32 s68, 0
L_lw_46:
    ds_read_b32 v7, v1 offset:0
    s_waitcnt lgkmcnt(0)
    v_readfirstlane_b32 s70, v7
    s_nop 0
    s_cmp_ge_u32 s70, 8
    s_cbranch_scc1 L_lwd_47
    s_sleep 2
    s_add_u32 s68, s68, 1
    s_cmp_lt_u32 s68, 0x200000
    s_cbranch_scc1 L_lw_46
L_lwd_47:
    s_and_b32 s76, s60, 3
    s_lshl_b32 s76, s76, 2
    s_add_u32 s76, s76, s59
    s_mul_i32 s76, s76, 1024
    s_add_u32 s76, s76, 0x60000
    v_mul_u32_u24 v247, 16, v0
    s_setprio 3
    buffer_load_dwordx2 v[22:23], v247, s[40:43], s76 offen sc1
    s_setprio 0
    ds_write_addtid_b32 v76 offset:0
    ds_write_addtid_b32 v77 offset:288
    ds_write_addtid_b32 v78 offset:576
    ds_write_addtid_b32 v79 offset:864
    ds_write_addtid_b32 v80 offset:1152
    ds_write_addtid_b32 v81 offset:1440
    ds_write_addtid_b32 v82 offset:1728
    ds_write_addtid_b32 v83 offset:2016
    ds_write_addtid_b32 v84 offset:2304
    ds_write_addtid_b32 v85 offset:2592
    ds_write_addtid_b32 v86 offset:2880
    ds_write_addtid_b32 v87 offset:3168
    ds_write_addtid_b32 v88 offset:3456
    ds_write_addtid_b32 v89 offset:3744
    ds_write_addtid_b32 v90 offset:4032
    ds_write_addtid_b32 v91 offset:4320
    ds_read_b128 v[24:27], v69 offset:0
    ds_read_b128 v[28:31], v69 offset:64
    ds_read_b128 v[32:35], v69 offset:128
    ds_read_b128 v[36:39], v69 offset:192
    ds_write_addtid_b32 v92 offset:0
    ds_write_addtid_b32 v93 offset:288
    ds_write_addtid_b32 v94 offset:576
    ds_write_addtid_b32 v95 offset:864
    ds_write_addtid_b32 v96 offset:1152
    ds_write_addtid_b32 v97 offset:1440
    ds_write_addtid_b32 v98 offset:1728
    ds_write_addtid_b32 v99 offset:2016
    ds_write_addtid_b32 v100 offset:2304
    ds_write_addtid_b32 v101 offset:2592
    ds_write_addtid_b32 v102 offset:2880
    ds_write_addtid_b32 v103 offset:3168
    ds_write_addtid_b32 v104 offset:3456
    ds_write_addtid_b32 v105 offset:3744
    ds_write_addtid_b32 v106 offset:4032
    ds_write_addtid_b32 v107 offset:4320
    ds_read_b128 v[40:43], v69 offset:0
    ds_read_b128 v[44:47], v69 offset:64
    ds_read_b128 v[48:51], v69 offset:128
    ds_read_b128 v[52:55], v69 offset:192
    ds_write_addtid_b32 v108 offset:0
    ds_write_addtid_b32 v109 offset:288
    ds_write_addtid_b32 v110 offset:576
    ds_write_addtid_b32 v111 offset:864
    ds_write_addtid_b32 v112 offset:1152
    ds_write_addtid_b32 v113 offset:1440
    ds_write_addtid_b32 v114 offset:1728
    ds_write_addtid_b32 v115 offset:2016
    ds_write_addtid_b32 v116 offset:2304
    ds_write_addtid_b32 v117 offset:2592
    ds_write_addtid_b32 v118 offset:2880
    ds_write_addtid_b32 v119 offset:3168
    ds_write_addtid_b32 v120 offset:3456
    ds_write_addtid_b32 v121 offset:3744
    ds_write_addtid_b32 v122 offset:4032
    ds_write_addtid_b32 v123 offset:4320
    s_waitcnt lgkmcnt(15)
    v_mfma_f32_16x16x32_bf16 v[10:13], v[40:43], v[24:27], 0
    v_mfma_f32_16x16x32_bf16 v[10:13], v[44:47], v[28:31], v[10:13]
    v_mfma_f32_16x16x32_bf16 v[10:13], v[48:51], v[32:35], v[10:13]
    v_mfma_f32_16x16x32_bf16 v[10:13], v[52:55], v[36:39], v[10:13]
    ds_read_b128 v[40:43], v69 offset:0
    ds_read_b128 v[44:47], v69 offset:64
    ds_read_b128 v[48:51], v69 offset:128
    ds_read_b128 v[52:55], v69 offset:192
    ds_write_addtid_b32 v124 offset:0
    ds_write_addtid_b32 v125 offset:288
    ds_write_addtid_b32 v126 offset:576
    ds_write_addtid_b32 v127 offset:864
    ds_write_addtid_b32 v128 offset:1152
    ds_write_addtid_b32 v129 offset:1440
    ds_write_addtid_b32 v130 offset:1728
    ds_write_addtid_b32 v131 offset:2016
    ds_write_addtid_b32 v132 offset:2304
    s_waitcnt lgkmcnt(9)
    v_mfma_f32_16x16x32_bf16 v[14:17], v[40:43], v[24:27], 0
    v_mfma_f32_16x16x32_bf16 v[14:17], v[44:47], v[28:31], v[14:17]
    v_mfma_f32_16x16x32_bf16 v[14:17], v[48:51], v[32:35], v[14:17]
    v_mfma_f32_16x16x32_bf16 v[14:17], v[52:55], v[36:39], v[14:17]
    ds_read_b128 v[40:43], v69 offset:0
    ds_read_b128 v[44:47], v69 offset:64
    ds_read_b128 v[48:51], v69 offset:128
    ds_read_b128 v[52:55], v69 offset:192
    s_waitcnt vmcnt(0)
    s_setprio 3
    v_cmp_ne_u64 vcc, s[56:57], v[22:23]
    s_cbranch_vccz L_pb_48
    s_mov_b32 s68, 0
L_pl_49:
    buffer_load_dwordx2 v[22:23], v247, s[40:43], s76 offen sc1
    s_waitcnt vmcnt(0)
    v_cmp_ne_u64_e64 vcc, s[56:57], v[22:23]
    s_nop 0
    s_and_b64 exec, exec, vcc
    s_cbranch_scc0 L_pld_50
    s_sleep 4
    s_add_u32 s68, s68, 1
    s_cmp_lt_u32 s68, 0x40000
    s_cbranch_scc1 L_pl_49
L_pld_50:
    s_mov_b64 exec, -1
L_pb_48:
    s_setprio 3
    buffer_load_dwordx4 v[80:83], v5, s[40:43], s71 offen offset:0 sc1
    buffer_load_dwordx4 v[84:87], v5, s[40:43], s71 offen offset:1024 sc1
    buffer_load_dwordx4 v[88:91], v5, s[40:43], s71 offen offset:2048 sc1
    buffer_load_dwordx4 v[92:95], v5, s[40:43], s71 offen offset:3072 sc1
    s_setprio 0
    ds_write_addtid_b32 v133 offset:0
    ds_write_addtid_b32 v134 offset:288
    ds_write_addtid_b32 v135 offset:576
    ds_write_addtid_b32 v136 offset:864
    ds_write_addtid_b32 v137 offset:1152
    ds_write_addtid_b32 v138 offset:1440
    ds_write_addtid_b32 v139 offset:1728
    ds_write_addtid_b32 v140 offset:2016
    ds_write_addtid_b32 v141 offset:2304
    ds_write_addtid_b32 v142 offset:2592
    ds_write_addtid_b32 v143 offset:2880
    ds_write_addtid_b32 v144 offset:3168
    ds_write_addtid_b32 v145 offset:3456
    ds_write_addtid_b32 v146 offset:3744
    ds_write_addtid_b32 v147 offset:4032
    ds_write_addtid_b32 v148 offset:4320
    s_waitcnt lgkmcnt(15)
    v_mfma_f32_16x16x32_bf16 v[18:21], v[40:43], v[24:27], 0
    v_mfma_f32_16x16x32_bf16 v[18:21], v[44:47], v[28:31], v[18:21]
    v_mfma_f32_16x16x32_bf16 v[18:21], v[48:51], v[32:35], v[18:21]
    v_mfma_f32_16x16x32_bf16 v[18:21], v[52:55], v[36:39], v[18:21]
    ds_read_b128 v[24:27], v69 offset:0
    ds_read_b128 v[28:31], v69 offset:64
    ds_read_b128 v[32:35], v69 offset:128
    ds_read_b128 v[36:39], v69 offset:192
    ds_write_addtid_b32 v149 offset:0
    ds_write_addtid_b32 v150 offset:288
    ds_write_addtid_b32 v151 offset:576
    ds_write_addtid_b32 v152 offset:864
    ds_write_addtid_b32 v153 offset:1152
    ds_write_addtid_b32 v154 offset:1440
    ds_write_addtid_b32 v155 offset:1728
    ds_write_addtid_b32 v156 offset:2016
    ds_write_addtid_b32 v157 offset:2304
    ds_write_addtid_b32 v158 offset:2592
    ds_write_addtid_b32 v159 offset:2880
    ds_write_addtid_b32 v160 offset:3168
    ds_write_addtid_b32 v161 offset:3456
    ds_write_addtid_b32 v162 offset:3744
    ds_write_addtid_b32 v163 offset:4032
    ds_write_addtid_b32 v164 offset:4320
    ds_read_b128 v[40:43], v69 offset:0
    ds_read_b128 v[44:47], v69 offset:64
    ds_read_b128 v[48:51], v69 offset:128
    ds_read_b128 v[52:55], v69 offset:192
    ds_write_addtid_b32 v165 offset:0
    ds_write_addtid_b32 v166 offset:288
    ds_write_addtid_b32 v167 offset:576
    ds_write_addtid_b32 v168 offset:864
    ds_write_addtid_b32 v169 offset:1152
    ds_write_addtid_b32 v170 offset:1440
    ds_write_addtid_b32 v171 offset:1728
    ds_write_addtid_b32 v172 offset:2016
    ds_write_addtid_b32 v173 offset:2304
    ds_write_addtid_b32 v174 offset:2592
    ds_write_addtid_b32 v175 offset:2880
    ds_write_addtid_b32 v176 offset:3168
    ds_write_addtid_b32 v177 offset:3456
    ds_write_addtid_b32 v178 offset:3744
    ds_write_addtid_b32 v179 offset:4032
    ds_write_addtid_b32 v180 offset:4320
    s_waitcnt lgkmcnt(15)
    v_mfma_f32_16x16x32_bf16 v[10:13], v[40:43], v[24:27], v[10:13]
    v_mfma_f32_16x16x32_bf16 v[10:13], v[44:47], v[28:31], v[10:13]
    v_mfma_f32_16x16x32_bf16 v[10:13], v[48:51], v[32:35], v[10:13]
    v_mfma_f32_16x16x32_bf16 v[10:13], v[52:55], v[36:39], v[10:13]
    ds_read_b128 v[40:43], v69 offset:0
    ds_read_b128 v[44:47], v69 offset:64
    ds_read_b128 v[48:51], v69 offset:128
    ds_read_b128 v[52:55], v69 offset:192
    ds_write_addtid_b32 v181 offset:0
    ds_write_addtid_b32 v182 offset:288
    ds_write_addtid_b32 v183 offset:576
    ds_write_addtid_b32 v184 offset:864
    ds_write_addtid_b32 v185 offset:1152
    ds_write_addtid_b32 v186 offset:1440
    ds_write_addtid_b32 v187 offset:1728
    ds_write_addtid_b32 v188 offset:2016
    ds_write_addtid_b32 v189 offset:2304
    s_waitcnt lgkmcnt(9)
    v_mfma_f32_16x16x32_bf16 v[14:17], v[40:43], v[24:27], v[14:17]
    v_mfma_f32_16x16x32_bf16 v[14:17], v[44:47], v[28:31], v[14:17]
    v_mfma_f32_16x16x32_bf16 v[14:17], v[48:51], v[32:35], v[14:17]
    v_mfma_f32_16x16x32_bf16 v[14:17], v[52:55], v[36:39], v[14:17]
    ds_read_b128 v[40:43], v69 offset:0
    ds_read_b128 v[44:47], v69 offset:64
    ds_read_b128 v[48:51], v69 offset:128
    ds_read_b128 v[52:55], v69 offset:192
    ds_write_addtid_b32 v190 offset:0
    ds_write_addtid_b32 v191 offset:288
    ds_write_addtid_b32 v192 offset:576
    ds_write_addtid_b32 v193 offset:864
    ds_write_addtid_b32 v194 offset:1152
    ds_write_addtid_b32 v195 offset:1440
    ds_write_addtid_b32 v196 offset:1728
    ds_write_addtid_b32 v197 offset:2016
    ds_write_addtid_b32 v198 offset:2304
    ds_write_addtid_b32 v199 offset:2592
    ds_write_addtid_b32 v200 offset:2880
    ds_write_addtid_b32 v201 offset:3168
    ds_write_addtid_b32 v202 offset:3456
    ds_write_addtid_b32 v203 offset:3744
    ds_write_addtid_b32 v204 offset:4032
    ds_write_addtid_b32 v205 offset:4320
    s_waitcnt lgkmcnt(15)
    v_mfma_f32_16x16x32_bf16 v[18:21], v[40:43], v[24:27], v[18:21]
    v_mfma_f32_16x16x32_bf16 v[18:21], v[44:47], v[28:31], v[18:21]
    v_mfma_f32_16x16x32_bf16 v[18:21], v[48:51], v[32:35], v[18:21]
    v_mfma_f32_16x16x32_bf16 v[18:21], v[52:55], v[36:39], v[18:21]
    ds_read_b128 v[24:27], v69 offset:0
    ds_read_b128 v[28:31], v69 offset:64
    ds_read_b128 v[32:35], v69 offset:128
    ds_read_b128 v[36:39], v69 offset:192
    ds_write_addtid_b32 v206 offset:0
    ds_write_addtid_b32 v207 offset:288
    ds_write_addtid_b32 v208 offset:576
    ds_write_addtid_b32 v209 offset:864
    ds_write_addtid_b32 v210 offset:1152
    ds_write_addtid_b32 v211 offset:1440
    ds_write_addtid_b32 v212 offset:1728
    ds_write_addtid_b32 v213 offset:2016
    ds_write_addtid_b32 v214 offset:2304
    ds_write_addtid_b32 v215 offset:2592
    ds_write_addtid_b32 v216 offset:2880
    ds_write_addtid_b32 v217 offset:3168
    ds_write_addtid_b32 v218 offset:3456
    ds_write_addtid_b32 v219 offset:3744
    ds_write_addtid_b32 v220 offset:4032
    ds_write_addtid_b32 v221 offset:4320
    ds_read_b128 v[40:43], v69 offset:0
    ds_read_b128 v[44:47], v69 offset:64
    ds_read_b128 v[48:51], v69 offset:128
    ds_read_b128 v[52:55], v69 offset:192
    ds_write_addtid_b32 v222 offset:0
    ds_write_addtid_b32 v223 offset:288
    ds_write_addtid_b32 v224 offset:576
    ds_write_addtid_b32 v225 offset:864
    ds_write_addtid_b32 v226 offset:1152
    ds_write_addtid_b32 v227 offset:1440
    ds_write_addtid_b32 v228 offset:1728
    ds_write_addtid_b32 v229 offset:2016
    ds_write_addtid_b32 v230 offset:2304
    ds_write_addtid_b32 v231 offset:2592
    ds_write_addtid_b32 v232 offset:2880
    ds_write_addtid_b32 v233 offset:3168
    ds_write_addtid_b32 v234 offset:3456
    ds_write_addtid_b32 v235 offset:3744
    ds_write_addtid_b32 v236 offset:4032
    ds_write_addtid_b32 v237 offset:4320
    s_waitcnt lgkmcnt(15)
    v_mfma_f32_16x16x32_bf16 v[10:13], v[40:43], v[24:27], v[10:13]
    v_mfma_f32_16x16x32_bf16 v[10:13], v[44:47], v[28:31], v[10:13]
    v_mfma_f32_16x16x32_bf16 v[10:13], v[48:51], v[32:35], v[10:13]
    v_mfma_f32_16x16x32_bf16 v[10:13], v[52:55], v[36:39], v[10:13]
    ds_read_b128 v[40:43], v69 offset:0
    ds_read_b128 v[44:47], v69 offset:64
    ds_read_b128 v[48:51], v69 offset:128
    ds_read_b128 v[52:55], v69 offset:192
    ds_write_addtid_b32 v238 offset:0
    ds_write_addtid_b32 v239 offset:288
    ds_write_addtid_b32 v240 offset:576
    ds_write_addtid_b32 v241 offset:864
    ds_write_addtid_b32 v242 offset:1152
    ds_write_addtid_b32 v243 offset:1440
    ds_write_addtid_b32 v244 offset:1728
    ds_write_addtid_b32 v245 offset:2016
    ds_write_addtid_b32 v246 offset:2304
    s_waitcnt lgkmcnt(9)
    v_mfma_f32_16x16x32_bf16 v[14:17], v[40:43], v[24:27], v[14:17]
    v_mfma_f32_16x16x32_bf16 v[14:17], v[44:47], v[28:31], v[14:17]
    v_mfma_f32_16x16x32_bf16 v[14:17], v[48:51], v[32:35], v[14:17]
    v_mfma_f32_16x16x32_bf16 v[14:17], v[52:55], v[36:39], v[14:17]
    ds_read_b128 v[40:43], v69 offset:0
    ds_read_b128 v[44:47], v69 offset:64
    ds_read_b128 v[48:51], v69 offset:128
    ds_read_b128 v[52:55], v69 offset:192
    s_waitcnt lgkmcnt(0)
    s_nop 0
    v_mfma_f32_16x16x32_bf16 v[18:21], v[40:43], v[24:27], v[18:21]
    v_mfma_f32_16x16x32_bf16 v[18:21], v[44:47], v[28:31], v[18:21]
    v_mfma_f32_16x16x32_bf16 v[18:21], v[48:51], v[32:35], v[18:21]
    v_mfma_f32_16x16x32_bf16 v[18:21], v[52:55], v[36:39], v[18:21]
    v_cvt_pk_bf16_f32 v24, v10, v11
    v_cvt_pk_bf16_f32 v25, v12, v13
    v_cvt_pk_bf16_f32 v26, v14, v15
    v_cvt_pk_bf16_f32 v27, v16, v17
    s_nop 3
    v_cvt_pk_bf16_f32 v28, v18, v19
    v_cvt_pk_bf16_f32 v29, v20, v21
    ds_write_b64 v70, v[24:25]
    ds_write_b32 v71, v26
    ds_write_b32 v72, v27
    ds_write_b16 v73, v28
    ds_write_b16_d16_hi v73, v28 offset:32
    ds_write_b16 v73, v29 offset:64
    ds_write_b16_d16_hi v73, v29 offset:96
    ds_read_u16 v120, v60 offset:0
    ds_read_u16 v140, v61 offset:0
    ds_read_u16 v121, v62 offset:192
    ds_read_u16 v141, v63 offset:192
    ds_read_u16 v122, v62 offset:128
    ds_read_u16 v142, v63 offset:128
    ds_read_u16 v123, v62 offset:64
    ds_read_u16 v143, v63 offset:64
    ds_read_u16 v124, v62 offset:0
    ds_read_u16 v144, v63 offset:0
    ds_read_u16 v125, v64 offset:128
    ds_read_u16 v145, v65 offset:128
    ds_read_u16 v126, v64 offset:0
    ds_read_u16 v146, v65 offset:0
    ds_read_u16 v127, v66 offset:256
    ds_read_u16 v147, v67 offset:256
    ds_read_u16 v128, v66 offset:0
    ds_read_u16 v148, v67 offset:0
    v_mov_b32 v96, 0
    v_mov_b32 v97, 0
    v_mov_b32 v98, 0
    v_mov_b32_e64 v99, 0
    s_add_u32 m0, s79, 968
    s_mov_b64 exec, 0x7fff
    ds_write_addtid_b32 v96
    s_mov_b64 exec, -1
    s_sub_u32 m0, s78, 192
    s_mov_b64 exec, 0xffffffff
    ds_write_b128 v9, v[96:99]
    s_mov_b64 exec, -1
    s_waitcnt vmcnt(3)
    ds_write_b128 v6, v[80:83] offset:0
    s_waitcnt vmcnt(2)
    ds_write_b128 v6, v[84:87] offset:256
    s_waitcnt vmcnt(1)
    ds_write_b128 v6, v[88:91] offset:512
    s_waitcnt vmcnt(0)
    ds_write_b128 v6, v[92:95] offset:768
    s_waitcnt lgkmcnt(0)
    s_mov_b64 exec, 1
    ds_add_u32 v1, v3 offset:20
    s_mov_b64 exec, -1
    v_cmp_le_u32 vcc, 58, v0
    s_nop 1
    v_cndmask_b32 v120, 0, v120, vcc
    v_cndmask_b32_e64 v140, 0, v140, vcc
    v_lshl_or_b32 v160, v140, 16, v120
    v_lshl_or_b32 v161, v141, 16, v121
    v_lshl_or_b32 v162, v142, 16, v122
    v_lshl_or_b32 v163, v143, 16, v123
    v_lshl_or_b32 v164, v144, 16, v124
    v_lshl_or_b32 v165, v145, 16, v125
    v_lshl_or_b32 v166, v146, 16, v126
    v_lshl_or_b32 v167, v147, 16, v127
    v_lshl_or_b32 v168, v148, 16, v128
    s_mov_b32 exec_lo, 0
    s_mov_b32 exec_hi, 0xffff0000
    ds_write_addtid_b32 v160 offset:0
    s_mov_b64 exec, -1
    ds_write_addtid_b32 v161 offset:256
    ds_write_addtid_b32 v162 offset:512
    ds_write_addtid_b32 v163 offset:768
    ds_write_addtid_b32 v164 offset:1024
    ds_write_addtid_b32 v165 offset:1280
    ds_write_addtid_b32 v166 offset:1536
    ds_write_addtid_b32 v167 offset:1792
    ds_write_addtid_b32 v168 offset:2048
    s_mov_b64 exec, 0xffff
    ds_write_addtid_b32 v96 offset:2304
    ds_write_addtid_b32 v96 offset:4544
    s_mov_b64 exec, -1
    ds_read_addtid_b32 v120 offset:4
    ds_read_addtid_b32 v121 offset:260
    ds_read_addtid_b32 v122 offset:516
    ds_read_addtid_b32 v123 offset:772
    ds_read_addtid_b32 v124 offset:1028
    ds_read_addtid_b32 v125 offset:1284
    ds_read_addtid_b32 v126 offset:1540
    ds_read_addtid_b32 v127 offset:1796
    ds_read_addtid_b32 v128 offset:2052
    v_and_b32 v60, 15, v0
    v_lshrrev_b32_e64 v61, 4, v0
    v_lshl_add_u32 v62, v61, 2, v60
    v_lshlrev_b32 v60, 1, v60
    v_sub_u32 v60, v61, v60
    v_lshlrev_b32_e64 v60, 4, v60
    s_add_u32 s70, s77, 448
    v_add_u32_e64 v60, s70, v60
    s_add_u32 s70, s79, 968
    v_lshlrev_b32 v61, 2, v62
    v_add_u32 v61, s70, v61
    v_subrev_u32 v62, 512, v75
    s_waitcnt lgkmcnt(0)
    s_nop 0
    v_alignbit_b32 v140, v120, v160, 16
    v_alignbit_b32 v141, v121, v161, 16
    v_alignbit_b32 v142, v122, v162, 16
    v_alignbit_b32 v143, v123, v163, 16
    v_alignbit_b32 v144, v124, v164, 16
    v_alignbit_b32 v145, v125, v165, 16
    v_alignbit_b32 v146, v126, v166, 16
    v_alignbit_b32 v147, v127, v167, 16
    v_alignbit_b32 v148, v128, v168, 16
    s_mov_b32 exec_lo, 0
    s_mov_b32 exec_hi, 0xffff0000
    ds_write_addtid_b32 v140 offset:2240
    s_mov_b64 exec, -1
    ds_write_addtid_b32 v141 offset:2496
    ds_write_addtid_b32 v142 offset:2752
    ds_write_addtid_b32 v143 offset:3008
    ds_write_addtid_b32 v144 offset:3264
    ds_write_addtid_b32 v145 offset:3520
    ds_write_addtid_b32 v146 offset:3776
    ds_write_addtid_b32 v147 offset:4032
    ds_write_addtid_b32 v148 offset:4288
    ds_read2_b32 v[240:241], v62 offset0:0 offset1:1
    ds_read2_b32 v[242:243], v62 offset0:2 offset1:3
    ds_read2_b32 v[112:113], v74 offset0:128 offset1:129
    ds_read2_b32 v[114:115], v74 offset0:130 offset1:131
    ds_read2_b32 v[116:117], v74 offset0:0 offset1:1
    ds_read2_b32 v[118:119], v74 offset0:2 offset1:3
    ds_read2_b32 v[120:121], v75 offset0:128 offset1:129
    ds_read2_b32 v[122:123], v75 offset0:130 offset1:131
    ds_read2_b32 v[124:125], v75 offset0:0 offset1:1
    ds_read2_b32 v[126:127], v75 offset0:2 offset1:3
    s_mov_b32 s68, 0
L_lw_51:
    ds_read_b32 v7, v1 offset:20
    s_waitcnt lgkmcnt(0)
    v_readfirstlane_b32 s70, v7
    s_nop 0
    s_cmp_ge_u32 s70, 4
    s_cbranch_scc1 L_lwd_52
    s_sleep 1
    s_add_u32 s68, s68, 1
    s_cmp_lt_u32 s68, 0x200000
    s_cbranch_scc1 L_lw_51
L_lwd_52:
    ds_read2_b32 v[80:81], v61 offset0:0 offset1:1
    ds_read2_b32 v[82:83], v61 offset0:2 offset1:3
    ds_read2_b32 v[84:85], v61 offset0:16 offset1:17
    ds_read2_b32 v[86:87], v61 offset0:18 offset1:19
    ds_read2_b32 v[88:89], v61 offset0:32 offset1:33
    ds_read2_b32 v[90:91], v61 offset0:34 offset1:35
    ds_read2_b32 v[92:93], v61 offset0:48 offset1:49
    ds_read2_b32 v[94:95], v61 offset0:50 offset1:51
    ds_read_b128 v[208:211], v60 offset:0
    ds_read_b128 v[212:215], v60 offset:16
    ds_read_b128 v[216:219], v60 offset:512
    ds_read_b128 v[220:223], v60 offset:528
    ds_read_b128 v[224:227], v60 offset:1024
    ds_read_b128 v[228:231], v60 offset:1040
    ds_read_b128 v[232:235], v60 offset:1536
    ds_read_b128 v[236:239], v60 offset:1552
    s_waitcnt lgkmcnt(0)
    ds_read_b128 v[128:131], v68 offset:0
    ds_read_b128 v[132:135], v68 offset:512
    ds_read_b128 v[136:139], v68 offset:1024
    ds_read_b128 v[140:143], v68 offset:1536
    ds_read_b128 v[144:147], v68 offset:2048
    ds_read_b128 v[148:151], v68 offset:2560
    ds_read_b128 v[152:155], v68 offset:3072
    ds_read_b128 v[156:159], v68 offset:3584
    s_waitcnt lgkmcnt(0)
    s_mov_b32 s68, 0
L_lw_53:
    ds_read_b32 v7, v1 offset:8
    s_waitcnt lgkmcnt(0)
    v_readfirstlane_b32 s71, v7
    s_nop 0
    s_cmp_ge_u32 s71, 4
    s_cbranch_scc1 L_lwd_54
    s_sleep 2
    s_add_u32 s68, s68, 1
    s_cmp_lt_u32 s68, 0x200000
    s_cbranch_scc1 L_lw_53
L_lwd_54:
    s_setprio 1
    s_nop 0
    v_mfma_f32_16x16x32_bf16 v[96:99], v[208:211], v[248:251], 0
    v_mfma_f32_16x16x32_bf16 v[100:103], v[212:215], v[252:255], 0
    v_mfma_f32_16x16x32_bf16 v[104:107], v[216:219], v[248:251], 0
    v_mfma_f32_16x16x32_bf16 v[108:111], v[220:223], v[252:255], 0
    v_mfma_f32_16x16x32_bf16 v[10:13], v[56:59], v[128:131], 0
    v_mfma_f32_16x16x32_bf16 v[14:17], v[56:59], v[132:135], 0
    v_mfma_f32_16x16x32_bf16 v[18:21], v[56:59], v[136:139], 0
    v_mfma_f32_16x16x32_bf16 v[22:25], v[56:59], v[140:143], 0
    v_mfma_f32_16x16x32_bf16 v[26:29], v[56:59], v[144:147], 0
    v_mfma_f32_16x16x32_bf16 v[30:33], v[56:59], v[148:151], 0
    v_mfma_f32_16x16x32_bf16 v[34:37], v[56:59], v[152:155], 0
    v_mfma_f32_16x16x32_bf16 v[38:41], v[56:59], v[156:159], 0
    v_cvt_pk_bf16_f32 v208, v100, v96
    v_cvt_pk_bf16_f32 v209, v101, v97
    v_cvt_pk_bf16_f32 v210, v102, v98
    v_cvt_pk_bf16_f32 v211, v103, v99
    v_cvt_pk_bf16_f32 v216, v108, v104
    v_cvt_pk_bf16_f32 v217, v109, v105
    v_cvt_pk_bf16_f32 v218, v110, v106
    v_cvt_pk_bf16_f32 v219, v111, v107
    v_mfma_f32_16x16x32_bf16 v[96:99], v[224:227], v[248:251], 0
    v_mfma_f32_16x16x32_bf16 v[100:103], v[228:231], v[252:255], 0
    v_mfma_f32_16x16x32_bf16 v[104:107], v[232:235], v[248:251], 0
    v_mfma_f32_16x16x32_bf16 v[108:111], v[236:239], v[252:255], 0
    v_mfma_f32_16x16x32_bf16 v[26:29], v[240:243], v[128:131], v[26:29]
    v_mfma_f32_16x16x32_bf16 v[30:33], v[240:243], v[132:135], v[30:33]
    v_mfma_f32_16x16x32_bf16 v[34:37], v[240:243], v[136:139], v[34:37]
    v_mfma_f32_16x16x32_bf16 v[38:41], v[240:243], v[140:143], v[38:41]
    v_mfma_f32_16x16x32_bf16 v[26:29], v[208:211], v[80:83], v[26:29]
    v_mfma_f32_16x16x32_bf16 v[30:33], v[208:211], v[84:87], v[30:33]
    v_mfma_f32_16x16x32_bf16 v[34:37], v[208:211], v[88:91], v[34:37]
    v_mfma_f32_16x16x32_bf16 v[38:41], v[208:211], v[92:95], v[38:41]
    v_mfma_f32_16x16x32_bf16 v[30:33], v[216:219], v[80:83], v[30:33]
    v_mfma_f32_16x16x32_bf16 v[34:37], v[216:219], v[84:87], v[34:37]
    v_mfma_f32_16x16x32_bf16 v[38:41], v[216:219], v[88:91], v[38:41]
    v_cvt_pk_bf16_f32 v224, v100, v96
    v_cvt_pk_bf16_f32 v225, v101, v97
    v_cvt_pk_bf16_f32 v226, v102, v98
    v_cvt_pk_bf16_f32 v227, v103, v99
    v_cvt_pk_bf16_f32 v232, v108, v104
    v_cvt_pk_bf16_f32 v233, v109, v105
    v_cvt_pk_bf16_f32 v234, v110, v106
    v_cvt_pk_bf16_f32 v235, v111, v107
    v_mfma_f32_16x16x32_bf16 v[34:37], v[224:227], v[80:83], v[34:37]
    v_mfma_f32_16x16x32_bf16 v[38:41], v[224:227], v[84:87], v[38:41]
    v_mfma_f32_16x16x32_bf16 v[38:41], v[232:235], v[80:83], v[38:41]
    s_mov_b32 s70, 0
L_cv:
    v_subrev_u32 v74, 64, v74
    v_subrev_u32 v75, 64, v75
    v_subrev_u32_e64 v68, 64, v68
    s_waitcnt lgkmcnt(0)
    v_mfma_f32_16x16x32_bf16 v[10:13], v[112:115], v[128:131], v[10:13]
    ds_read2_b32 v[160:161], v74 offset0:128 offset1:129
    v_mfma_f32_16x16x32_bf16 v[14:17], v[112:115], v[132:135], v[14:17]
    ds_read2_b32 v[162:163], v74 offset0:130 offset1:131
    v_mfma_f32_16x16x32_bf16 v[18:21], v[112:115], v[136:139], v[18:21]
    ds_read_b128 v[176:179], v68 offset:0
    v_mfma_f32_16x16x32_bf16 v[22:25], v[112:115], v[140:143], v[22:25]
    ds_read_b128 v[180:183], v68 offset:512
    v_mfma_f32_16x16x32_bf16 v[26:29], v[112:115], v[144:147], v[26:29]
    ds_read_b128 v[184:187], v68 offset:1024
    v_mfma_f32_16x16x32_bf16 v[30:33], v[112:115], v[148:151], v[30:33]
    ds_read_b128 v[188:191], v68 offset:1536
    v_mfma_f32_16x16x32_bf16 v[34:37], v[112:115], v[152:155], v[34:37]
    ds_read_b128 v[192:195], v68 offset:2048
    v_mfma_f32_16x16x32_bf16 v[38:41], v[112:115], v[156:159], v[38:41]
    ds_read_b128 v[196:199], v68 offset:2560
    v_mfma_f32_16x16x32_bf16 v[14:17], v[116:119], v[128:131], v[14:17]
    ds_read_b128 v[200:203], v68 offset:3072
    v_mfma_f32_16x16x32_bf16 v[18:21], v[116:119], v[132:135], v[18:21]
    ds_read_b128 v[204:207], v68 offset:3584
    v_mfma_f32_16x16x32_bf16 v[22:25], v[116:119], v[136:139], v[22:25]
    ds_read2_b32 v[164:165], v74 offset0:0 offset1:1
    v_mfma_f32_16x16x32_bf16 v[26:29], v[116:119], v[140:143], v[26:29]
    ds_read2_b32 v[166:167], v74 offset0:2 offset1:3
    v_mfma_f32_16x16x32_bf16 v[30:33], v[116:119], v[144:147], v[30:33]
    ds_read2_b32 v[168:169], v75 offset0:128 offset1:129
    v_mfma_f32_16x16x32_bf16 v[34:37], v[116:119], v[148:151], v[34:37]
    ds_read2_b32 v[170:171], v75 offset0:130 offset1:131
    v_mfma_f32_16x16x32_bf16 v[38:41], v[116:119], v[152:155], v[38:41]
    ds_read2_b32 v[172:173], v75 offset0:0 offset1:1
    v_mfma_f32_16x16x32_bf16 v[18:21], v[120:123], v[128:131], v[18:21]
    ds_read2_b32 v[174:175], v75 offset0:2 offset1:3
    v_mfma_f32_16x16x32_bf16 v[22:25], v[120:123], v[132:135], v[22:25]
    v_mfma_f32_16x16x32_bf16 v[26:29], v[120:123], v[136:139], v[26:29]
    v_mfma_f32_16x16x32_bf16 v[30:33], v[120:123], v[140:143], v[30:33]
    v_mfma_f32_16x16x32_bf16 v[34:37], v[120:123], v[144:147], v[34:37]
    v_mfma_f32_16x16x32_bf16 v[38:41], v[120:123], v[148:151], v[38:41]
    v_mfma_f32_16x16x32_bf16 v[22:25], v[124:127], v[128:131], v[22:25]
    v_mfma_f32_16x16x32_bf16 v[26:29], v[124:127], v[132:135], v[26:29]
    v_mfma_f32_16x16x32_bf16 v[30:33], v[124:127], v[136:139], v[30:33]
    v_mfma_f32_16x16x32_bf16 v[34:37], v[124:127], v[140:143], v[34:37]
    v_mfma_f32_16x16x32_bf16 v[38:41], v[124:127], v[144:147], v[38:41]
    v_subrev_u32 v74, 64, v74
    v_subrev_u32 v75, 64, v75
    v_subrev_u32 v68, 64, v68
    s_waitcnt lgkmcnt(0)
    v_mfma_f32_16x16x32_bf16 v[10:13], v[160:163], v[176:179], v[10:13]
    ds_read2_b32 v[112:113], v74 offset0:128 offset1:129
    v_mfma_f32_16x16x32_bf16 v[14:17], v[160:163], v[180:183], v[14:17]
    ds_read2_b32 v[114:115], v74 offset0:130 offset1:131
    v_mfma_f32_16x16x32_bf16 v[18:21], v[160:163], v[184:187], v[18:21]
    ds_read_b128 v[128:131], v68 offset:0
    v_mfma_f32_16x16x32_bf16 v[22:25], v[160:163], v[188:191], v[22:25]
    ds_read_b128 v[132:135], v68 offset:512
    v_mfma_f32_16x16x32_bf16 v[26:29], v[160:163], v[192:195], v[26:29]
    ds_read_b128 v[136:139], v68 offset:1024
    v_mfma_f32_16x16x32_bf16 v[30:33], v[160:163], v[196:199], v[30:33]
    ds_read_b128 v[140:143], v68 offset:1536
    v_mfma_f32_16x16x32_bf16 v[34:37], v[160:163], v[200:203], v[34:37]
    ds_read_b128 v[144:147], v68 offset:2048
    v_mfma_f32_16x16x32_bf16 v[38:41], v[160:163], v[204:207], v[38:41]
    ds_read_b128 v[148:151], v68 offset:2560
    v_mfma_f32_16x16x32_bf16 v[14:17], v[164:167], v[176:179], v[14:17]
    ds_read_b128 v[152:155], v68 offset:3072
    v_mfma_f32_16x16x32_bf16 v[18:21], v[164:167], v[180:183], v[18:21]
    ds_read_b128 v[156:159], v68 offset:3584
    v_mfma_f32_16x16x32_bf16 v[22:25], v[164:167], v[184:187], v[22:25]
    ds_read2_b32 v[116:117], v74 offset0:0 offset1:1
    v_mfma_f32_16x16x32_bf16 v[26:29], v[164:167], v[188:191], v[26:29]
    ds_read2_b32 v[118:119], v74 offset0:2 offset1:3
    v_mfma_f32_16x16x32_bf16 v[30:33], v[164:167], v[192:195], v[30:33]
    ds_read2_b32 v[120:121], v75 offset0:128 offset1:129
    v_mfma_f32_16x16x32_bf16 v[34:37], v[164:167], v[196:199], v[34:37]
    ds_read2_b32 v[122:123], v75 offset0:130 offset1:131
    v_mfma_f32_16x16x32_bf16 v[38:41], v[164:167], v[200:203], v[38:41]
    ds_read2_b32 v[124:125], v75 offset0:0 offset1:1
    v_mfma_f32_16x16x32_bf16 v[18:21], v[168:171], v[176:179], v[18:21]
    ds_read2_b32 v[126:127], v75 offset0:2 offset1:3
    v_mfma_f32_16x16x32_bf16 v[22:25], v[168:171], v[180:183], v[22:25]
    v_mfma_f32_16x16x32_bf16 v[26:29], v[168:171], v[184:187], v[26:29]
    v_mfma_f32_16x16x32_bf16 v[30:33], v[168:171], v[188:191], v[30:33]
    v_mfma_f32_16x16x32_bf16 v[34:37], v[168:171], v[192:195], v[34:37]
    v_mfma_f32_16x16x32_bf16 v[38:41], v[168:171], v[196:199], v[38:41]
    v_mfma_f32_16x16x32_bf16 v[22:25], v[172:175], v[176:179], v[22:25]
    v_mfma_f32_16x16x32_bf16 v[26:29], v[172:175], v[180:183], v[26:29]
    v_mfma_f32_16x16x32_bf16 v[30:33], v[172:175], v[184:187], v[30:33]
    v_mfma_f32_16x16x32_bf16 v[34:37], v[172:175], v[188:191], v[34:37]
    v_mfma_f32_16x16x32_bf16 v[38:41], v[172:175], v[192:195], v[38:41]
    s_add_u32 s70, s70, 2
    s_cmp_lt_u32 s70, 8
    s_cbranch_scc1 L_cv
    s_setprio 3
    v_cvt_pk_bf16_f32 v80, v10, v12
    v_cvt_pk_bf16_f32 v81, v11, v13
    v_cvt_pk_bf16_f32 v82, v14, v16
    v_cvt_pk_bf16_f32 v83, v15, v17
    v_cvt_pk_bf16_f32 v84, v18, v20
    v_cvt_pk_bf16_f32 v85, v19, v21
    v_cvt_pk_bf16_f32 v86, v22, v24
    v_cvt_pk_bf16_f32 v87, v23, v25
    v_cvt_pk_bf16_f32 v88, v26, v28
    v_cvt_pk_bf16_f32 v89, v27, v29
    v_cvt_pk_bf16_f32 v90, v30, v32
    v_cvt_pk_bf16_f32 v91, v31, v33
    v_cvt_pk_bf16_f32 v92, v34, v36
    v_cvt_pk_bf16_f32 v93, v35, v37
    v_cvt_pk_bf16_f32 v94, v38, v40
    v_cvt_pk_bf16_f32 v95, v39, v41
    ds_write2st64_b32 v8, v80, v81 offset0:0 offset1:8
    ds_write2st64_b32 v8, v82, v83 offset0:1 offset1:9
    ds_write2st64_b32 v8, v84, v85 offset0:2 offset1:10
    ds_write2st64_b32 v8, v86, v87 offset0:3 offset1:11
    ds_write2st64_b32 v8, v88, v89 offset0:4 offset1:12
    ds_write2st64_b32 v8, v90, v91 offset0:5 offset1:13
    ds_write2st64_b32 v8, v92, v93 offset0:6 offset1:14
    ds_write2st64_b32 v8, v94, v95 offset0:7 offset1:15
    s_waitcnt lgkmcnt(0)
    s_mov_b64 exec, 1
    ds_add_u32 v1, v3 offset:12
    s_mov_b64 exec, -1
    s_mov_b32 s68, 0
L_lw_55:
    ds_read_b32 v7, v1 offset:12
    s_waitcnt lgkmcnt(0)
    v_readfirstlane_b32 s70, v7
    s_nop 0
    s_cmp_ge_u32 s70, 4
    s_cbranch_scc1 L_lwd_56
    s_sleep 1
    s_add_u32 s68, s68, 1
    s_cmp_lt_u32 s68, 0x200000
    s_cbranch_scc1 L_lw_55
L_lwd_56:
    ds_read_b64_tr_b16 v[120:121], v4 offset:0
    ds_read_b64_tr_b16 v[122:123], v4 offset:2048
    ds_read_b64_tr_b16 v[124:125], v4 offset:128
    ds_read_b64_tr_b16 v[126:127], v4 offset:2176
    ds_read_b64_tr_b16 v[128:129], v4 offset:256
    ds_read_b64_tr_b16 v[130:131], v4 offset:2304
    ds_read_b64_tr_b16 v[132:133], v4 offset:384
    ds_read_b64_tr_b16 v[134:135], v4 offset:2432
    s_waitcnt lgkmcnt(6)
    buffer_store_dwordx4 v[120:123], v2, s[40:43], s73 offen offset:0 sc1
    s_waitcnt lgkmcnt(4)
    buffer_store_dwordx4 v[124:127], v2, s[40:43], s73 offen offset:1024 sc1
    s_waitcnt lgkmcnt(2)
    buffer_store_dwordx4 v[128:131], v2, s[40:43], s73 offen offset:2048 sc1
    s_waitcnt lgkmcnt(0)
    buffer_store_dwordx4 v[132:135], v2, s[40:43], s73 offen offset:3072 sc1
    s_waitcnt vmcnt(0)
    v_mov_b32 v10, s56
    v_mov_b32 v11, s57
    s_mov_b64 exec, 1
    buffer_store_dwordx2 v[10:11], v1, s[40:43], s72 offen sc1
    s_mov_b64 exec, -1
L_S_exit:
    s_endpgm
L_send1:
    s_setprio 3
    v_mov_b32 v34, s56
    v_mov_b32 v35, s57
    s_mov_b64 exec, 1
    buffer_store_dwordx2 v[34:35], v9, s[40:43], s72 offen sc1
    s_mov_b64 exec, -1
    s_cmp_lg_u32 s69, 0
    s_cbranch_scc0 L_send1_b
    buffer_store_dwordx4 v[36:39], v48, s[40:43], s76 offen sc1
    s_add_u32 s70, s76, 0x100000
    buffer_store_dwordx4 v[40:43], v48, s[40:43], s70 offen sc1
    s_add_u32 s70, s76, s3
    buffer_store_dwordx4 v[44:47], v48, s[40:43], s70 offen sc1
    s_add_u32 s72, s72, 0x50000
    s_mov_b32 s69, 0
    s_setprio 0
    s_setpc_b64 s[74:75]
L_send1_b:
    s_setprio 0
    s_mov_b32 s73, 1
    s_setpc_b64 s[74:75]
L_end:
    s_endpgm
    .fill 401, 4, 0xbf810000
.section .rodata,"a"
.p2align 6
.amdhsa_kernel parallel_sum__ssm_conv_s4d__mixer_token_mlp__prompt_kernel
  .amdhsa_next_free_vgpr 256
  .amdhsa_next_free_sgpr 102
  .amdhsa_accum_offset 256
  .amdhsa_group_segment_fixed_size 0
  .amdhsa_kernarg_size 120
  .amdhsa_user_sgpr_count 2
  .amdhsa_user_sgpr_kernarg_segment_ptr 1
  .amdhsa_system_sgpr_workgroup_id_x 1
.end_amdhsa_kernel
```
